```python
import torch

def _softmax(x, axis=-1):
    return torch.softmax(x, dim=axis)
def _gelu(x):
    return torch.nn.functional.gelu(x, approximate="tanh")
def _silu(x):
    return torch.nn.functional.silu(x)
def _sigmoid(x):
    return torch.sigmoid(x)
def _layernorm(x, axis=-1, eps=1e-5):
    m = x.mean(dim=axis, keepdim=True)
    v = x.var(dim=axis, keepdim=True, unbiased=False)
    return (x - m) / torch.sqrt(v + eps)
def _scatter_add(tgt, idx, src, axis=0):
    return tgt.clone().index_add_(axis, idx, src)
def _segment_sum(src, seg, n):
    out = torch.zeros((n,) + src.shape[1:], dtype=src.dtype)
    return out.index_add_(0, seg, src)
def _pad(x, pw):
    flat = tuple(v for pair in reversed(pw) for v in pair)
    return torch.nn.functional.pad(x, flat)

kernel_name = 'gather_scatter__cheap_equivariant_egnn__graph'

def setup_inputs():

    _w = (lambda a: (lambda t: t.to(torch.bfloat16) if t.is_floating_point() else t)(torch.as_tensor(a)))
    N, deg, D, De = 50000, 16, 64, max(16, 1)
    E = N * deg
    return {
        "h": _w((lambda *s: torch.randn(*s, dtype=torch.bfloat16) * 0.2)(N, D)),
        "pos": _w((lambda *s: torch.randn(*s, dtype=torch.bfloat16) * 0.8)(N, 3)),
        "e_attr": _w((lambda *s: torch.randn(*s, dtype=torch.bfloat16) * 0.8)(E, De)),
        "src": _w((lambda lo, hi, *s: torch.randint(lo, hi, s))(0, N, E).to(torch.int64)),
        "dst": _w((lambda lo, hi, *s: torch.randint(lo, hi, s))(0, N, E).to(torch.int64)),
        "w_e": _w(0.1 * (lambda *s: torch.randn(*s, dtype=torch.bfloat16) * 0.8)(2 * D + 1 + De, D)),
        "w_x": _w(0.1 * (lambda *s: torch.randn(*s, dtype=torch.bfloat16) * 0.2)(D, 1)),
        "w_h": _w(0.1 * (lambda *s: torch.randn(*s, dtype=torch.bfloat16) * 0.2)(2 * D, D)),
    }

def reference(h, pos, e_attr, src, dst, w_e, w_x, w_h):
    N, D = h.shape[0], h.shape[1]
    diff = pos[dst] - pos[src]
    dist2 = torch.sum(diff * diff, axis=-1, keepdims=True)
    e_in = torch.concatenate([h[dst], h[src], dist2, e_attr], axis=-1)
    m_ij = _silu(e_in @ w_e)
    coord_scale = m_ij @ w_x
    pos_new = pos + _segment_sum(diff * coord_scale, dst, N)
    m_i = _segment_sum(m_ij, dst, N)
    h_new = h + _silu(torch.concatenate([h, m_i], axis=-1) @ w_h)
    return h_new, pos_new
```

```asm
; @launch kernel=egnn_sort_kernel grid=(256,1,1) block=(512,1,1) lds=27136
; @launch kernel=gather_scatter__cheap_equivariant_egnn__graph_kernel grid=(256,1,1) block=(512,1,1) lds=163840
.amdgcn_target "amdgcn-amd-amdhsa--gfx950"
.text
.globl egnn_sort_kernel
.p2align 8
.type egnn_sort_kernel,@function
egnn_sort_kernel:
  s_cmp_ge_u32 s2, 256
  s_cbranch_scc1 K1_END
  s_load_dwordx4 s[4:7], s[0:1], 24
  s_load_dwordx2 s[8:9], s[0:1], 40
  s_load_dwordx2 s[10:11], s[0:1], 56
  s_load_dwordx2 s[12:13], s[0:1], 80
  s_load_dwordx2 s[14:15], s[0:1], 8
  v_and_b32 v1, 255, v0
  v_lshlrev_b32 v1, 2, v1
  v_mov_b32 v2, 0
  ds_write_b32 v1, v2
  v_lshrrev_b32 v3, 6, v0
  s_mul_i32 s3, s2, 3125
  s_movk_i32 s29, 8192
  s_mov_b32 s31, 175921861
  s_movk_i32 s67, 3125
  v_mov_b32 v7, 127
  v_readfirstlane_b32 s65, v3
  v_lshlrev_b32 v8, 2, v0
  v_add_u32 v4, s3, v8
  v_lshlrev_b32 v5, 2, v4
  s_cmp_eq_u32 s65, 7
  s_cselect_b32 s66, 1, 0
  s_cmp_lt_u32 s2, 36
  s_cselect_b32 s66, s66, 0
  s_waitcnt lgkmcnt(0)
  s_mov_b32 s20, s6
  s_and_b32 s21, s7, 0xffff
  s_mov_b32 s22, 3200000
  s_mov_b32 s23, 0x00020000
  buffer_load_dwordx4 v[10:13], v5, s[20:23], 0 offen
  buffer_load_dwordx4 v[14:17], v5, s[20:23], s29 offen
  s_mov_b32 s16, s4
  s_and_b32 s17, s5, 0xffff
  s_mov_b32 s18, 3200000
  s_mov_b32 s19, 0x00020000
  buffer_load_dwordx4 v[18:21], v5, s[16:19], 0 offen
  buffer_load_dwordx4 v[22:25], v5, s[16:19], s29 offen
  s_mov_b32 s24, s12
  s_and_b32 s25, s13, 0xffff
  s_mov_b32 s26, 16777216
  s_mov_b32 s27, 0x00020000
  s_mov_b32 s60, s14
  s_and_b32 s61, s15, 0xffff
  s_mov_b32 s62, 300000
  s_mov_b32 s63, 0x00020000
  s_mul_i32 s64, s2, 196
  v_add_u32 v96, s64, v0
  v_mul_u32_u24 v97, 6, v96
  v_lshlrev_b32 v96, 3, v96
  buffer_load_ushort v98, v97, s[60:63], 0 offen
  buffer_load_ushort v99, v97, s[60:63], 0 offen offset:2
  buffer_load_ushort v97, v97, s[60:63], 0 offen offset:4
  v_mov_b32 v6, 1
  s_movk_i32 s28, 1077
  v_cmp_gt_u32 s[68:69], s28, v8
  s_movk_i32 s28, 1076
  v_cmp_gt_u32 s[70:71], s28, v8
  s_movk_i32 s28, 1075
  v_cmp_gt_u32 s[72:73], s28, v8
  s_movk_i32 s28, 1074
  v_cmp_gt_u32 s[74:75], s28, v8
  s_cmp_eq_u32 s66, 0
  s_cbranch_scc1 K1_NOW
  s_cmp_ge_u32 s2, 20
  s_cbranch_scc1 K1_WH
  s_mov_b32 s44, s8
  s_and_b32 s45, s9, 0xffff
  s_mov_b32 s46, 18560
  s_mov_b32 s47, 0x00020000
  s_lshr_b32 s38, s2, 1
  s_lshl_b32 s40, s38, 4
  s_mov_b32 s41, 8
  s_mov_b32 s42, 4
  s_mov_b32 s43, 1
  s_cmp_lt_u32 s38, 8
  s_cbranch_scc1 K1_WGO
  s_movk_i32 s40, 129
  s_cmp_eq_u32 s38, 8
  s_cbranch_scc1 K1_WGO
  s_movk_i32 s40, 128
  s_movk_i32 s41, 0
  s_movk_i32 s42, 4096
  s_movk_i32 s43, 4096
  s_branch K1_WGO
K1_WH:
  s_mov_b32 s44, s10
  s_and_b32 s45, s11, 0xffff
  s_mov_b32 s46, 16384
  s_mov_b32 s47, 0x00020000
  s_sub_u32 s38, s2, 20
  s_lshr_b32 s38, s38, 1
  s_lshl_b32 s40, s38, 4
  s_mov_b32 s41, 8
  s_mov_b32 s42, 4
  s_mov_b32 s43, 1
  s_cmp_lt_u32 s38, 4
  s_cbranch_scc1 K1_WGO
  s_mov_b32 s41, 4
  s_mov_b32 s42, 8
K1_WGO:
  v_bfe_u32 v80, v0, 5, 1
  v_mul_lo_u32 v80, v80, s41
  v_add_u32 v80, s40, v80
  v_lshlrev_b32 v80, 7, v80
  v_and_b32 v81, 31, v0
  s_and_b32 s39, s2, 1
  s_lshl_b32 s39, s39, 5
  v_add_u32 v81, s39, v81
  v_lshl_add_u32 v80, v81, 1, v80
  s_mul_i32 s48, s42, 0
  s_mul_i32 s49, s43, 0
  s_add_u32 s50, s48, s49
  s_mul_i32 s48, s42, 0
  s_mul_i32 s49, s43, 128
  s_add_u32 s51, s48, s49
  s_mul_i32 s48, s42, 0
  s_mul_i32 s49, s43, 256
  s_add_u32 s52, s48, s49
  s_mul_i32 s48, s42, 0
  s_mul_i32 s49, s43, 384
  s_add_u32 s53, s48, s49
  s_mul_i32 s48, s42, 128
  s_mul_i32 s49, s43, 0
  s_add_u32 s54, s48, s49
  s_mul_i32 s48, s42, 128
  s_mul_i32 s49, s43, 128
  s_add_u32 s55, s48, s49
  s_mul_i32 s48, s42, 128
  s_mul_i32 s49, s43, 256
  s_add_u32 s56, s48, s49
  s_mul_i32 s48, s42, 128
  s_mul_i32 s49, s43, 384
  s_add_u32 s57, s48, s49
  buffer_load_ushort v82, v80, s[44:47], s50 offen
  buffer_load_ushort v83, v80, s[44:47], s51 offen
  buffer_load_ushort v84, v80, s[44:47], s52 offen
  buffer_load_ushort v85, v80, s[44:47], s53 offen
  buffer_load_ushort v86, v80, s[44:47], s54 offen
  buffer_load_ushort v87, v80, s[44:47], s55 offen
  buffer_load_ushort v88, v80, s[44:47], s56 offen
  buffer_load_ushort v89, v80, s[44:47], s57 offen
  s_barrier
  s_waitcnt vmcnt(13)
  s_branch K1_GO
K1_NOW:
  s_sub_u32 s37, s2, 64
  s_lshl_b32 s37, s37, 9
  v_add_u32 v80, s37, v0
  v_and_b32 v81, 0x1fff, v80
  v_lshrrev_b32 v82, 13, v80
  v_lshl_or_b32 v81, v82, 15, v81
  v_lshlrev_b32 v81, 16, v81
  v_mul_f32 v81, 0x62800000, v81
  v_mul_f32 v82, 0xbfb8aa3b, v81
  v_exp_f32 v82, v82
  s_nop 0
  v_add_f32 v82, 1.0, v82
  v_rcp_f32 v82, v82
  s_nop 0
  v_mul_f32 v81, v81, v82
  v_cvt_pk_bf16_f32 v81, v81, v81
  v_lshlrev_b32 v80, 1, v80
  s_barrier
  s_waitcnt vmcnt(5)
K1_GO:
  v_mul_hi_u32 v26, v10, s31
  v_mul_hi_u32 v27, v11, s31
  v_mul_hi_u32 v28, v12, s31
  v_mul_hi_u32 v29, v13, s31
  v_lshrrev_b32 v42, 1, v26
  v_lshrrev_b32 v43, 1, v27
  v_lshrrev_b32 v44, 1, v28
  v_lshrrev_b32 v45, 1, v29
  v_and_b32 v42, 0xfffffffc, v42
  v_and_b32 v43, 0xfffffffc, v43
  v_and_b32 v44, 0xfffffffc, v44
  v_and_b32 v45, 0xfffffffc, v45
  ds_add_rtn_u32 v50, v42, v6
  ds_add_rtn_u32 v51, v43, v6
  ds_add_rtn_u32 v52, v44, v6
  ds_add_rtn_u32 v53, v45, v6
  s_cmp_ge_u32 s65, 5
  s_cbranch_scc1 K1_A
  v_mul_hi_u32 v30, v14, s31
  v_mul_hi_u32 v31, v15, s31
  v_mul_hi_u32 v32, v16, s31
  v_mul_hi_u32 v33, v17, s31
  v_lshrrev_b32 v46, 1, v30
  v_lshrrev_b32 v47, 1, v31
  v_lshrrev_b32 v48, 1, v32
  v_lshrrev_b32 v49, 1, v33
  v_and_b32 v46, 0xfffffffc, v46
  v_and_b32 v47, 0xfffffffc, v47
  v_and_b32 v48, 0xfffffffc, v48
  v_and_b32 v49, 0xfffffffc, v49
  s_mov_b64 exec, s[68:69]
  ds_add_rtn_u32 v54, v46, v6
  s_mov_b64 exec, s[70:71]
  ds_add_rtn_u32 v55, v47, v6
  s_mov_b64 exec, s[72:73]
  ds_add_rtn_u32 v56, v48, v6
  s_mov_b64 exec, s[74:75]
  ds_add_rtn_u32 v57, v49, v6
  s_mov_b64 exec, -1
  v_mad_u32_u24 v38, v30, s67, v7
  v_mad_u32_u24 v39, v31, s67, v7
  v_mad_u32_u24 v40, v32, s67, v7
  v_mad_u32_u24 v41, v33, s67, v7
  v_lshrrev_b32 v38, 7, v38
  v_lshrrev_b32 v39, 7, v39
  v_lshrrev_b32 v40, 7, v40
  v_lshrrev_b32 v41, 7, v41
  v_sub_u32 v38, v14, v38
  v_sub_u32 v39, v15, v39
  v_sub_u32 v40, v16, v40
  v_sub_u32 v41, v17, v41
  v_and_b32 v30, 7, v30
  v_and_b32 v31, 7, v31
  v_and_b32 v32, 7, v32
  v_and_b32 v33, 7, v33
  v_add_u32 v14, 5, v30
  v_add_u32 v15, 5, v31
  v_add_u32 v16, 5, v32
  v_add_u32 v17, 5, v33
  v_lshrrev_b32 v14, 3, v14
  v_lshrrev_b32 v15, 3, v15
  v_lshrrev_b32 v16, 3, v16
  v_lshrrev_b32 v17, 3, v17
  v_add3_u32 v30, v30, v14, 1
  v_add3_u32 v31, v31, v15, 1
  v_add3_u32 v32, v32, v16, 1
  v_add3_u32 v33, v33, v17, 1
  v_add_u32 v68, 2048, v4
  v_add_u32 v70, 2049, v4
  v_add_u32 v72, 2050, v4
  v_add_u32 v74, 2051, v4
  v_lshl_or_b32 v68, v30, 27, v68
  v_lshl_or_b32 v70, v31, 27, v70
  v_lshl_or_b32 v72, v32, 27, v72
  v_lshl_or_b32 v74, v33, 27, v74
K1_A:
  v_mad_u32_u24 v34, v26, s67, v7
  v_mad_u32_u24 v35, v27, s67, v7
  v_mad_u32_u24 v36, v28, s67, v7
  v_mad_u32_u24 v37, v29, s67, v7
  v_lshrrev_b32 v34, 7, v34
  v_lshrrev_b32 v35, 7, v35
  v_lshrrev_b32 v36, 7, v36
  v_lshrrev_b32 v37, 7, v37
  v_sub_u32 v34, v10, v34
  v_sub_u32 v35, v11, v35
  v_sub_u32 v36, v12, v36
  v_sub_u32 v37, v13, v37
  v_and_b32 v26, 7, v26
  v_and_b32 v27, 7, v27
  v_and_b32 v28, 7, v28
  v_and_b32 v29, 7, v29
  v_add_u32 v10, 5, v26
  v_add_u32 v11, 5, v27
  v_add_u32 v12, 5, v28
  v_add_u32 v13, 5, v29
  v_lshrrev_b32 v10, 3, v10
  v_lshrrev_b32 v11, 3, v11
  v_lshrrev_b32 v12, 3, v12
  v_lshrrev_b32 v13, 3, v13
  v_add3_u32 v26, v26, v10, 1
  v_add3_u32 v27, v27, v11, 1
  v_add3_u32 v28, v28, v12, 1
  v_add3_u32 v29, v29, v13, 1
  v_add_u32 v60, 0, v4
  v_add_u32 v62, 1, v4
  v_add_u32 v64, 2, v4
  v_add_u32 v66, 3, v4
  v_lshl_or_b32 v60, v26, 27, v60
  v_lshl_or_b32 v62, v27, 27, v62
  v_lshl_or_b32 v64, v28, 27, v64
  v_lshl_or_b32 v66, v29, 27, v66
  v_and_b32 v1, 63, v0
  v_lshlrev_b32 v3, 12, v1
  v_lshlrev_b32 v1, 4, v1
  s_waitcnt lgkmcnt(0)
  s_barrier
  ds_read_b128 v[10:13], v1
  s_waitcnt lgkmcnt(0)
  v_add_u32 v76, v10, v11
  v_add_u32 v77, v12, v13
  v_add_u32 v77, v76, v77
  v_mov_b32 v78, v77
  s_nop 1
  v_add_u32_dpp v78, v78, v78 row_shr:1 row_mask:0xf bank_mask:0xf
  s_nop 1
  v_add_u32_dpp v78, v78, v78 row_shr:2 row_mask:0xf bank_mask:0xf
  s_nop 1
  v_add_u32_dpp v78, v78, v78 row_shr:4 row_mask:0xf bank_mask:0xf
  s_nop 1
  v_add_u32_dpp v78, v78, v78 row_shr:8 row_mask:0xf bank_mask:0xf
  s_nop 1
  v_add_u32_dpp v78, v78, v78 row_bcast:15 row_mask:0xa bank_mask:0xf
  s_nop 1
  v_add_u32_dpp v78, v78, v78 row_bcast:31 row_mask:0xc bank_mask:0xf
  s_nop 1
  v_sub_u32 v14, v78, v77
  v_add_u32 v15, v14, v10
  v_add_u32 v16, v14, v76
  v_add_u32 v17, v16, v12
  ds_write_b128 v1, v[14:17] offset:1024
  ds_read_b32 v26, v42 offset:1024
  ds_read_b32 v27, v43 offset:1024
  ds_read_b32 v28, v44 offset:1024
  ds_read_b32 v29, v45 offset:1024
  s_cmp_lg_u32 s65, 0
  s_cbranch_scc1 K1_B
  v_lshl_or_b32 v76, v10, 16, v14
  v_lshl_or_b32 v77, v11, 16, v15
  v_lshl_or_b32 v78, v12, 16, v16
  v_lshl_or_b32 v79, v13, 16, v17
  s_lshl_b32 s35, s2, 2
  s_add_u32 s35, s35, 8388608
  buffer_store_dword v76, v3, s[24:27], s35 offen offset:0
  buffer_store_dword v77, v3, s[24:27], s35 offen offset:1024
  buffer_store_dword v78, v3, s[24:27], s35 offen offset:2048
  buffer_store_dword v79, v3, s[24:27], s35 offen offset:3072
  s_waitcnt vmcnt(4)
  s_branch K1_B2
K1_B:
  s_waitcnt vmcnt(0)
K1_B2:
  s_cmp_lt_u32 s65, 5
  s_cbranch_scc1 K1_C0
  s_waitcnt lgkmcnt(0)
  s_branch K1_C
K1_C0:
  ds_read_b32 v30, v46 offset:1024
  ds_read_b32 v31, v47 offset:1024
  ds_read_b32 v32, v48 offset:1024
  ds_read_b32 v33, v49 offset:1024
  v_lshl_or_b32 v69, v38, 16, v22
  v_lshl_or_b32 v71, v39, 16, v23
  v_lshl_or_b32 v73, v40, 16, v24
  v_lshl_or_b32 v75, v41, 16, v25
  s_waitcnt lgkmcnt(3)
  v_add_u32 v30, v30, v54
  v_lshlrev_b32 v30, 3, v30
  s_mov_b64 exec, s[68:69]
  ds_write_b64 v30, v[68:69] offset:2048
  s_mov_b64 exec, -1
  s_waitcnt lgkmcnt(3)
  v_add_u32 v31, v31, v55
  v_lshlrev_b32 v31, 3, v31
  s_mov_b64 exec, s[70:71]
  ds_write_b64 v31, v[70:71] offset:2048
  s_mov_b64 exec, -1
  s_waitcnt lgkmcnt(3)
  v_add_u32 v32, v32, v56
  v_lshlrev_b32 v32, 3, v32
  s_mov_b64 exec, s[72:73]
  ds_write_b64 v32, v[72:73] offset:2048
  s_mov_b64 exec, -1
  s_waitcnt lgkmcnt(3)
  v_add_u32 v33, v33, v57
  v_lshlrev_b32 v33, 3, v33
  s_mov_b64 exec, s[74:75]
  ds_write_b64 v33, v[74:75] offset:2048
  s_mov_b64 exec, -1
K1_C:
  v_lshl_or_b32 v61, v34, 16, v18
  v_lshl_or_b32 v63, v35, 16, v19
  v_lshl_or_b32 v65, v36, 16, v20
  v_lshl_or_b32 v67, v37, 16, v21
  s_waitcnt lgkmcnt(4)
  v_add_u32 v26, v26, v50
  v_lshlrev_b32 v26, 3, v26
  v_add_u32 v27, v27, v51
  v_lshlrev_b32 v27, 3, v27
  v_add_u32 v28, v28, v52
  v_lshlrev_b32 v28, 3, v28
  v_add_u32 v29, v29, v53
  v_lshlrev_b32 v29, 3, v29
  ds_write_b64 v26, v[60:61] offset:2048
  ds_write_b64 v27, v[62:63] offset:2048
  ds_write_b64 v28, v[64:65] offset:2048
  ds_write_b64 v29, v[66:67] offset:2048
  v_lshlrev_b32 v1, 4, v0
  s_mul_i32 s36, s2, 25088
  s_add_u32 s37, s36, 8192
  s_add_u32 s38, s36, 16384
  s_add_u32 s39, s36, 24576
  s_waitcnt lgkmcnt(0)
  s_barrier
  ds_read_b128 v[10:13], v1 offset:2048
  ds_read_b128 v[14:17], v1 offset:10240
  ds_read_b128 v[18:21], v1 offset:18432
  s_cmp_lg_u32 s65, 0
  s_cbranch_scc1 K1_E
  s_mov_b64 exec, 4294967295
  ds_read_b128 v[22:25], v1 offset:26624
  s_waitcnt lgkmcnt(0)
  buffer_store_dwordx4 v[22:25], v1, s[24:27], s39 offen
  s_mov_b64 exec, -1
K1_E:
  s_waitcnt lgkmcnt(2)
  buffer_store_dwordx4 v[10:13], v1, s[24:27], s36 offen
  s_waitcnt lgkmcnt(1)
  buffer_store_dwordx4 v[14:17], v1, s[24:27], s37 offen
  s_waitcnt lgkmcnt(0)
  buffer_store_dwordx4 v[18:21], v1, s[24:27], s38 offen
  s_cmp_ge_u32 s65, 4
  s_cbranch_scc1 K1_D
  v_lshl_or_b32 v98, v99, 16, v98
  v_mov_b32 v99, v97
  s_mov_b32 s64, 12713984
  v_cmp_gt_u32 vcc, 196, v0
  s_and_saveexec_b64 s[32:33], vcc
  buffer_store_dwordx2 v[98:99], v96, s[24:27], s64 offen
  s_mov_b64 exec, s[32:33]
K1_D:
  s_cmp_lg_u32 s66, 0
  s_cbranch_scc1 K1_WST
  s_cmp_lt_u32 s2, 64
  s_cbranch_scc1 K1_FIN
  s_cmp_ge_u32 s2, 96
  s_cbranch_scc1 K1_FIN
  s_mov_b32 s37, 12648448
  buffer_store_short v81, v80, s[24:27], s37 offen
  s_branch K1_FIN
K1_WST:
  v_lshlrev_b32 v82, 16, v82
  v_mul_f32 v82, 0x1c800000, v82
  v_lshrrev_b32 v82, 16, v82
  v_lshlrev_b32 v83, 16, v83
  v_mul_f32 v83, 0x1c800000, v83
  v_lshrrev_b32 v83, 16, v83
  v_lshlrev_b32 v84, 16, v84
  v_mul_f32 v84, 0x1c800000, v84
  v_lshrrev_b32 v84, 16, v84
  v_lshlrev_b32 v85, 16, v85
  v_mul_f32 v85, 0x1c800000, v85
  v_lshrrev_b32 v85, 16, v85
  v_lshlrev_b32 v86, 16, v86
  v_mul_f32 v86, 0x1c800000, v86
  v_lshrrev_b32 v86, 16, v86
  v_lshlrev_b32 v87, 16, v87
  v_mul_f32 v87, 0x1c800000, v87
  v_lshrrev_b32 v87, 16, v87
  v_lshlrev_b32 v88, 16, v88
  v_mul_f32 v88, 0x1c800000, v88
  v_lshrrev_b32 v88, 16, v88
  v_lshlrev_b32 v89, 16, v89
  v_mul_f32 v89, 0x1c800000, v89
  v_lshrrev_b32 v89, 16, v89
  v_lshl_or_b32 v92, v83, 16, v82
  v_lshl_or_b32 v93, v85, 16, v84
  v_lshl_or_b32 v94, v87, 16, v86
  v_lshl_or_b32 v95, v89, 16, v88
  v_and_b32 v81, 63, v0
  v_lshlrev_b32 v81, 4, v81
  s_lshl_b32 s48, s2, 10
  s_add_u32 s48, s48, 12582912
  buffer_store_dwordx4 v[92:95], v81, s[24:27], s48 offen
K1_FIN:
K1_END:
  s_endpgm
.globl gather_scatter__cheap_equivariant_egnn__graph_kernel
.p2align 8
.type gather_scatter__cheap_equivariant_egnn__graph_kernel,@function
gather_scatter__cheap_equivariant_egnn__graph_kernel:
  s_cmp_ge_u32 s2, 256
  s_cbranch_scc1 K2_END
  s_and_b32 s3, s2, 7
  s_lshl_b32 s3, s3, 5
  s_lshr_b32 s61, s2, 3
  s_add_u32 s3, s3, s61
  s_cmp_ge_u32 s3, 256
  s_cbranch_scc1 K2_END
  s_load_dwordx4 s[4:7], s[0:1], 0
  s_load_dwordx2 s[8:9], s[0:1], 16
  s_load_dwordx2 s[10:11], s[0:1], 48
  s_load_dwordx2 s[12:13], s[0:1], 64
  s_load_dwordx2 s[14:15], s[0:1], 80
  v_lshrrev_b32 v248, 6, v0
  v_lshlrev_b32 v255, 4, v0
  v_readfirstlane_b32 s61, v248
  v_and_b32 v0, 63, v0
  s_lshl_b32 s52, s3, 3
  s_add_u32 s52, s52, s61
  s_lshl_b32 s3, s52, 7
  s_add_u32 s3, s3, 8388608
  s_mul_i32 s64, s61, 100352
  s_lshr_b32 s65, s2, 3
  s_add_u32 s65, s65, s61
  s_and_b32 s65, s65, 7
  s_add_u32 s63, s65, 5
  s_lshr_b32 s63, s63, 3
  s_add_u32 s63, s63, s65
  s_add_u32 s63, s63, 1
  s_lshl_b32 s63, s63, 14
  s_mul_i32 s40, s52, 3125
  s_add_u32 s42, s40, 3252
  s_add_u32 s40, s40, 127
  s_lshr_b32 s40, s40, 7
  s_lshr_b32 s42, s42, 7
  s_sub_u32 s42, s42, s40
  s_mul_i32 s50, s61, 16384
  s_add_u32 s50, s50, 16384
  s_cmp_lt_u32 s61, 3
  s_cbranch_scc1 K2_B0
  s_add_u32 s50, s50, 16384
K2_B0:
  s_lshr_b32 s86, s50, 14
  s_lshl_b32 s97, s65, 10
  s_add_u32 s93, s50, 0
  s_add_u32 s94, s50, 1024
  s_add_u32 s95, s50, 2048
  s_add_u32 s96, s50, 3072
  s_mov_b32 s46, 0xbfb8aa3b
  s_mov_b32 s47, 0xbfb8aa3b
  s_mov_b32 s48, 1.0
  s_mov_b32 s49, 1.0
  s_mov_b32 s51, 0x07060302
  s_mov_b32 s54, 0x9fff9fff
  s_mov_b32 s56, 0xcccccccc
  s_mov_b32 s57, 0xcccccccc
  s_mov_b32 s58, 0xaaaaaaaa
  s_mov_b32 s59, 0xaaaaaaaa
  s_mov_b32 s60, 0xffff0000
  s_mov_b32 s68, 0x0f0f0f0f
  s_mov_b32 s69, 0xf0f0f0f0
  s_movk_i32 s88, 128
  s_movk_i32 s89, 144
  s_movk_i32 s90, 80
  s_mov_b32 s91, 12713984
  s_lshl_b32 s92, s40, 3
  s_add_u32 s92, s92, 12713984
  v_lshlrev_b32 v250, 4, v0
  v_mov_b32 v224, 0
  v_mov_b32 v225, 0
  v_mov_b32 v226, 0
  v_mov_b32 v227, 0
  v_add_u32 v252, s50, v250
  ds_write_b128 v252, v[224:227] offset:12816
  ds_write_b128 v252, v[224:227] offset:13840
  s_mov_b64 exec, 0x1ffff
  ds_write_b128 v252, v[224:227] offset:14864
  s_mov_b64 exec, 0xff
  ds_write_b128 v252, v[224:227] offset:12688
  s_mov_b64 exec, 15
  ds_write_b128 v252, v[224:227] offset:16160
  s_mov_b64 exec, -1
  v_lshrrev_b32 v249, 4, v0
  v_lshlrev_b32 v248, 5, v249
  s_waitcnt lgkmcnt(0)
  s_mov_b32 s28, s14
  s_and_b32 s29, s15, 0xffff
  s_mov_b32 s30, 16777216
  s_mov_b32 s31, 0x00020000
  buffer_load_dwordx4 v[128:131], v248, s[28:31], s3 offen
  buffer_load_dwordx4 v[132:135], v248, s[28:31], s3 offen offset:16
  s_barrier
  s_mov_b32 s16, s4
  s_and_b32 s17, s5, 0xffff
  s_mov_b32 s18, 6400000
  s_mov_b32 s19, 0x00020000
  s_mov_b32 s20, s6
  s_and_b32 s21, s7, 0xffff
  s_mov_b32 s22, 300000
  s_mov_b32 s23, 0x00020000
  s_mov_b32 s24, s8
  s_and_b32 s25, s9, 0xffff
  s_mov_b32 s26, 25600000
  s_mov_b32 s27, 0x00020000
  s_mov_b32 s32, s12
  s_and_b32 s33, s13, 0xffff
  s_mov_b32 s34, 6700000
  s_mov_b32 s35, 0x00020000
  s_mov_b32 s36, s10
  s_and_b32 s37, s11, 0xffff
  s_mov_b32 s38, 128
  s_mov_b32 s39, 0x00020000
  v_and_b32 v246, 31, v0
  v_lshrrev_b32 v247, 5, v0
  v_lshlrev_b32 v251, 1, v246
  v_lshlrev_b32 v252, 3, v246
  s_add_u32 s61, s97, 12582912
  s_add_u32 m0, s63, 0
  s_nop 0
  buffer_load_dwordx4 v250, s[28:31], s61 offen lds
  s_add_u32 s61, s61, 8192
  s_add_u32 m0, s63, 1024
  s_nop 0
  buffer_load_dwordx4 v250, s[28:31], s61 offen lds
  s_add_u32 s61, s61, 8192
  s_add_u32 m0, s63, 2048
  s_min_u32 s61, s61, 12602368
  buffer_load_dwordx4 v250, s[28:31], s61 offen lds
  s_add_u32 s61, s61, 8192
  v_and_b32 v248, 15, v0
  v_lshlrev_b32 v154, 17, v248
  v_or_b32 v154, 0xffff, v154
  v_add_u32 v155, 0x10000, v154
  v_mul_u32_u24 v156, 25088, v249
  v_add_u32 v156, s64, v156
  v_lshl_add_u32 v156, v248, 1, v156
  v_lshlrev_b32 v156, 3, v156
  v_mov_b32 v157, 4
  v_mov_b32 v192, -1
  v_mov_b32 v193, -1
  v_mov_b32 v194, -1
  v_mov_b32 v195, -1
  v_mov_b32 v196, -1
  v_mov_b32 v197, -1
  v_mov_b32 v198, -1
  v_mov_b32 v199, -1
  v_mov_b32 v200, -1
  v_mov_b32 v201, -1
  v_mov_b32 v202, -1
  v_mov_b32 v203, -1
  v_mov_b32 v204, -1
  v_mov_b32 v205, -1
  v_mov_b32 v206, -1
  v_mov_b32 v207, -1
  v_lshlrev_b32 v1, 4, v247
  v_add_u32 v2, s50, v1
  v_lshrrev_b32 v248, 4, v246
  v_lshlrev_b32 v3, 5, v248
  v_bfe_u32 v248, v246, 2, 1
  v_lshl_add_u32 v3, v248, 4, v3
  v_bfe_u32 v248, v246, 3, 1
  v_lshl_add_u32 v3, v248, 3, v3
  v_and_b32 v248, 3, v246
  v_lshl_add_u32 v3, v248, 1, v3
  v_add_u32 v3, 12816, v3
  v_add_u32 v3, s50, v3
  v_min_u32 v4, 25, v246
  v_mul_u32_u24 v4, 80, v4
  v_add_u32 v4, v4, v2
  v_add_u32 v4, 12816, v4
  v_lshl_add_u32 v5, v248, 6, v2
  v_add_u32 v5, 14880, v5
  v_mov_b32 v93, 0
  v_mov_b32 v94, 0
  v_mov_b32 v95, 0
  v_lshrrev_b32 v248, 3, v0
  v_lshrrev_b32 v249, 4, v0
  v_xor_b32 v248, v248, v249
  v_and_b32 v248, 1, v248
  v_lshlrev_b32 v248, 2, v248
  v_and_b32 v249, 7, v0
  v_xor_b32 v248, v248, v249
  v_xor_b32 v228, 0, v248
  v_lshlrev_b32 v228, 4, v228
  v_xor_b32 v229, 1, v248
  v_lshlrev_b32 v229, 4, v229
  v_xor_b32 v230, 2, v248
  v_lshlrev_b32 v230, 4, v230
  v_xor_b32 v231, 3, v248
  v_lshlrev_b32 v231, 4, v231
  v_lshrrev_b32 v248, 2, v246
  v_lshrrev_b32 v249, 3, v246
  v_xor_b32 v249, v248, v249
  v_and_b32 v249, 1, v249
  v_and_b32 v253, 3, v246
  v_lshl_or_b32 v249, v249, 2, v253
  v_xor_b32 v249, v249, v247
  v_lshlrev_b32 v248, 7, v248
  v_lshl_add_u32 v248, v253, 10, v248
  v_add_u32 v248, s50, v248
  v_xor_b32 v232, 0, v249
  v_lshl_add_u32 v232, v232, 4, v248
  v_xor_b32 v233, 2, v249
  v_lshl_add_u32 v233, v233, 4, v248
  v_xor_b32 v234, 4, v249
  v_lshl_add_u32 v234, v234, 4, v248
  v_xor_b32 v235, 6, v249
  v_lshl_add_u32 v235, v235, 4, v248
  v_mov_b32 v96, 0
  v_mov_b32 v97, 0
  v_mov_b32 v98, 0
  v_mov_b32 v99, 0
  v_mov_b32 v100, 0
  v_mov_b32 v101, 0
  v_mov_b32 v102, 0
  v_mov_b32 v103, 0
  v_mov_b32 v104, 0
  v_mov_b32 v105, 0
  v_mov_b32 v106, 0
  v_mov_b32 v107, 0
  v_mov_b32 v108, 0
  v_mov_b32 v109, 0
  v_mov_b32 v110, 0
  v_mov_b32 v111, 0
  v_mov_b32 v112, 0
  v_mov_b32 v113, 0
  v_mov_b32 v114, 0
  v_mov_b32 v115, 0
  v_mov_b32 v116, 0
  v_mov_b32 v117, 0
  v_mov_b32 v118, 0
  v_mov_b32 v119, 0
  v_mov_b32 v120, 0
  v_mov_b32 v121, 0
  v_mov_b32 v122, 0
  v_mov_b32 v123, 0
  v_mov_b32 v124, 0
  v_mov_b32 v125, 0
  v_mov_b32 v126, 0
  v_mov_b32 v127, 0
  v_mov_b32 v88, 0
  v_mov_b32 v89, 0
  v_mov_b32 v90, 0
  v_mov_b32 v91, 0
  s_waitcnt vmcnt(3)
  v_cmp_gt_u32 vcc, v128, v154
  v_mad_u32_u16 v208, v128, 8, v156
  s_mov_b32 s61, 0
  s_mov_b64 exec, vcc
  buffer_load_dwordx4 v[160:163], v208, s[28:31], s61 offen
  s_mov_b64 exec, -1
  v_cmp_gt_u32 vcc, v129, v154
  v_mad_u32_u16 v209, v129, 8, v156
  s_mov_b32 s61, 25088
  s_mov_b64 exec, vcc
  buffer_load_dwordx4 v[164:167], v209, s[28:31], s61 offen
  s_mov_b64 exec, -1
  v_cmp_gt_u32 vcc, v130, v154
  v_mad_u32_u16 v210, v130, 8, v156
  s_mov_b32 s61, 50176
  s_mov_b64 exec, vcc
  buffer_load_dwordx4 v[168:171], v210, s[28:31], s61 offen
  s_mov_b64 exec, -1
  v_cmp_gt_u32 vcc, v131, v154
  v_mad_u32_u16 v211, v131, 8, v156
  s_mov_b32 s61, 75264
  s_mov_b64 exec, vcc
  buffer_load_dwordx4 v[172:175], v211, s[28:31], s61 offen
  s_mov_b64 exec, -1
  v_cmp_gt_u32 vcc, v132, v154
  v_mad_u32_u16 v212, v132, 8, v156
  s_mov_b32 s61, 100352
  s_mov_b64 exec, vcc
  buffer_load_dwordx4 v[176:179], v212, s[28:31], s61 offen
  s_mov_b64 exec, -1
  v_cmp_gt_u32 vcc, v133, v154
  v_mad_u32_u16 v213, v133, 8, v156
  s_mov_b32 s61, 125440
  s_mov_b64 exec, vcc
  buffer_load_dwordx4 v[180:183], v213, s[28:31], s61 offen
  s_mov_b64 exec, -1
  v_cmp_gt_u32 vcc, v134, v154
  v_mad_u32_u16 v214, v134, 8, v156
  s_mov_b32 s61, 150528
  s_mov_b64 exec, vcc
  buffer_load_dwordx4 v[184:187], v214, s[28:31], s61 offen
  s_mov_b64 exec, -1
  v_cmp_gt_u32 vcc, v135, v154
  v_mad_u32_u16 v215, v135, 8, v156
  s_mov_b32 s61, 175616
  s_mov_b64 exec, vcc
  buffer_load_dwordx4 v[188:191], v215, s[28:31], s61 offen
  s_mov_b64 exec, -1
  v_max_u32 v158, v128, v129
  v_max3_u32 v158, v158, v130, v131
  v_max3_u32 v158, v158, v132, v133
  v_max3_u32 v158, v158, v134, v135
  s_movk_i32 s62, 2048
  s_waitcnt vmcnt(7)
  v_cmp_gt_u32 vcc, v128, v154
  v_lshrrev_b32 v208, 25, v160
  s_mov_b64 exec, vcc
  ds_add_rtn_u32 v192, v208, v157 offset:32544
  s_mov_b64 exec, -1
  v_cmp_gt_u32 vcc, v128, v155
  v_lshrrev_b32 v209, 25, v162
  s_mov_b64 exec, vcc
  ds_add_rtn_u32 v193, v209, v157 offset:32544
  s_mov_b64 exec, -1
  s_waitcnt vmcnt(6)
  v_cmp_gt_u32 vcc, v129, v154
  v_lshrrev_b32 v210, 25, v164
  s_mov_b64 exec, vcc
  ds_add_rtn_u32 v194, v210, v157 offset:32544
  s_mov_b64 exec, -1
  v_cmp_gt_u32 vcc, v129, v155
  v_lshrrev_b32 v211, 25, v166
  s_mov_b64 exec, vcc
  ds_add_rtn_u32 v195, v211, v157 offset:32544
  s_mov_b64 exec, -1
  s_waitcnt vmcnt(5)
  v_cmp_gt_u32 vcc, v130, v154
  v_lshrrev_b32 v212, 25, v168
  s_mov_b64 exec, vcc
  ds_add_rtn_u32 v196, v212, v157 offset:32544
  s_mov_b64 exec, -1
  v_cmp_gt_u32 vcc, v130, v155
  v_lshrrev_b32 v213, 25, v170
  s_mov_b64 exec, vcc
  ds_add_rtn_u32 v197, v213, v157 offset:32544
  s_mov_b64 exec, -1
  s_waitcnt vmcnt(4)
  v_cmp_gt_u32 vcc, v131, v154
  v_lshrrev_b32 v214, 25, v172
  s_mov_b64 exec, vcc
  ds_add_rtn_u32 v198, v214, v157 offset:32544
  s_mov_b64 exec, -1
  v_cmp_gt_u32 vcc, v131, v155
  v_lshrrev_b32 v215, 25, v174
  s_mov_b64 exec, vcc
  ds_add_rtn_u32 v199, v215, v157 offset:32544
  s_mov_b64 exec, -1
  s_waitcnt vmcnt(3)
  v_cmp_gt_u32 vcc, v132, v154
  v_lshrrev_b32 v216, 25, v176
  s_mov_b64 exec, vcc
  ds_add_rtn_u32 v200, v216, v157 offset:32544
  s_mov_b64 exec, -1
  v_cmp_gt_u32 vcc, v132, v155
  v_lshrrev_b32 v217, 25, v178
  s_mov_b64 exec, vcc
  ds_add_rtn_u32 v201, v217, v157 offset:32544
  s_mov_b64 exec, -1
  s_waitcnt vmcnt(2)
  v_cmp_gt_u32 vcc, v133, v154
  v_lshrrev_b32 v218, 25, v180
  s_mov_b64 exec, vcc
  ds_add_rtn_u32 v202, v218, v157 offset:32544
  s_mov_b64 exec, -1
  v_cmp_gt_u32 vcc, v133, v155
  v_lshrrev_b32 v219, 25, v182
  s_mov_b64 exec, vcc
  ds_add_rtn_u32 v203, v219, v157 offset:32544
  s_mov_b64 exec, -1
  s_waitcnt vmcnt(1)
  v_cmp_gt_u32 vcc, v134, v154
  v_lshrrev_b32 v220, 25, v184
  s_mov_b64 exec, vcc
  ds_add_rtn_u32 v204, v220, v157 offset:32544
  s_mov_b64 exec, -1
  v_cmp_gt_u32 vcc, v134, v155
  v_lshrrev_b32 v221, 25, v186
  s_mov_b64 exec, vcc
  ds_add_rtn_u32 v205, v221, v157 offset:32544
  s_mov_b64 exec, -1
  s_waitcnt vmcnt(0)
  v_cmp_gt_u32 vcc, v135, v154
  v_lshrrev_b32 v222, 25, v188
  s_mov_b64 exec, vcc
  ds_add_rtn_u32 v206, v222, v157 offset:32544
  s_mov_b64 exec, -1
  v_cmp_gt_u32 vcc, v135, v155
  v_lshrrev_b32 v223, 25, v190
  s_mov_b64 exec, vcc
  ds_add_rtn_u32 v207, v223, v157 offset:32544
  s_mov_b64 exec, -1
  s_waitcnt lgkmcnt(15)
  v_cmp_gt_u32 vcc, s62, v192
  v_lshl_add_u32 v208, v208, 12, v192
  s_mov_b64 exec, vcc
  ds_write2st64_b32 v208, v161, v160 offset0:16 offset1:26
  s_mov_b64 exec, -1
  s_waitcnt lgkmcnt(15)
  v_cmp_gt_u32 vcc, s62, v193
  v_lshl_add_u32 v209, v209, 12, v193
  s_mov_b64 exec, vcc
  ds_write2st64_b32 v209, v163, v162 offset0:16 offset1:26
  s_mov_b64 exec, -1
  s_waitcnt lgkmcnt(15)
  v_cmp_gt_u32 vcc, s62, v194
  v_lshl_add_u32 v210, v210, 12, v194
  s_mov_b64 exec, vcc
  ds_write2st64_b32 v210, v165, v164 offset0:16 offset1:26
  s_mov_b64 exec, -1
  s_waitcnt lgkmcnt(15)
  v_cmp_gt_u32 vcc, s62, v195
  v_lshl_add_u32 v211, v211, 12, v195
  s_mov_b64 exec, vcc
  ds_write2st64_b32 v211, v167, v166 offset0:16 offset1:26
  s_mov_b64 exec, -1
  s_waitcnt lgkmcnt(15)
  v_cmp_gt_u32 vcc, s62, v196
  v_lshl_add_u32 v212, v212, 12, v196
  s_mov_b64 exec, vcc
  ds_write2st64_b32 v212, v169, v168 offset0:16 offset1:26
  s_mov_b64 exec, -1
  s_waitcnt lgkmcnt(15)
  v_cmp_gt_u32 vcc, s62, v197
  v_lshl_add_u32 v213, v213, 12, v197
  s_mov_b64 exec, vcc
  ds_write2st64_b32 v213, v171, v170 offset0:16 offset1:26
  s_mov_b64 exec, -1
  s_waitcnt lgkmcnt(15)
  v_cmp_gt_u32 vcc, s62, v198
  v_lshl_add_u32 v214, v214, 12, v198
  s_mov_b64 exec, vcc
  ds_write2st64_b32 v214, v173, v172 offset0:16 offset1:26
  s_mov_b64 exec, -1
  s_waitcnt lgkmcnt(15)
  v_cmp_gt_u32 vcc, s62, v199
  v_lshl_add_u32 v215, v215, 12, v199
  s_mov_b64 exec, vcc
  ds_write2st64_b32 v215, v175, v174 offset0:16 offset1:26
  s_mov_b64 exec, -1
  s_waitcnt lgkmcnt(15)
  v_cmp_gt_u32 vcc, s62, v200
  v_lshl_add_u32 v216, v216, 12, v200
  s_mov_b64 exec, vcc
  ds_write2st64_b32 v216, v177, v176 offset0:16 offset1:26
  s_mov_b64 exec, -1
  s_waitcnt lgkmcnt(15)
  v_cmp_gt_u32 vcc, s62, v201
  v_lshl_add_u32 v217, v217, 12, v201
  s_mov_b64 exec, vcc
  ds_write2st64_b32 v217, v179, v178 offset0:16 offset1:26
  s_mov_b64 exec, -1
  s_waitcnt lgkmcnt(15)
  v_cmp_gt_u32 vcc, s62, v202
  v_lshl_add_u32 v218, v218, 12, v202
  s_mov_b64 exec, vcc
  ds_write2st64_b32 v218, v181, v180 offset0:16 offset1:26
  s_mov_b64 exec, -1
  s_waitcnt lgkmcnt(15)
  v_cmp_gt_u32 vcc, s62, v203
  v_lshl_add_u32 v219, v219, 12, v203
  s_mov_b64 exec, vcc
  ds_write2st64_b32 v219, v183, v182 offset0:16 offset1:26
  s_mov_b64 exec, -1
  s_waitcnt lgkmcnt(15)
  v_cmp_gt_u32 vcc, s62, v204
  v_lshl_add_u32 v220, v220, 12, v204
  s_mov_b64 exec, vcc
  ds_write2st64_b32 v220, v185, v184 offset0:16 offset1:26
  s_mov_b64 exec, -1
  s_waitcnt lgkmcnt(15)
  v_cmp_gt_u32 vcc, s62, v205
  v_lshl_add_u32 v221, v221, 12, v205
  s_mov_b64 exec, vcc
  ds_write2st64_b32 v221, v187, v186 offset0:16 offset1:26
  s_mov_b64 exec, -1
  s_waitcnt lgkmcnt(15)
  v_cmp_gt_u32 vcc, s62, v206
  v_lshl_add_u32 v222, v222, 12, v206
  s_mov_b64 exec, vcc
  ds_write2st64_b32 v222, v189, v188 offset0:16 offset1:26
  s_mov_b64 exec, -1
  s_waitcnt lgkmcnt(15)
  v_cmp_gt_u32 vcc, s62, v207
  v_lshl_add_u32 v223, v223, 12, v207
  s_mov_b64 exec, vcc
  ds_write2st64_b32 v223, v191, v190 offset0:16 offset1:26
  s_mov_b64 exec, -1
  s_lshl_b32 s61, s40, 7
  buffer_load_dwordx4 v[136:139], v250, s[16:19], s61 offen offset:0
  buffer_load_dwordx4 v[140:143], v250, s[16:19], s61 offen offset:1024
  buffer_load_dwordx4 v[144:147], v250, s[16:19], s61 offen offset:2048
  buffer_load_dwordx4 v[148:151], v250, s[16:19], s61 offen offset:3072
  buffer_load_ushort v13, v251, s[36:39], 0 offen
  buffer_load_ushort v15, v251, s[36:39], 0 offen offset:64
  buffer_load_dwordx2 v[152:153], v252, s[28:31], s92 offen
  s_add_u32 s61, s97, 12648448
  s_add_u32 m0, s97, 0
  s_nop 0
  buffer_load_dwordx4 v250, s[28:31], s61 offen lds
  s_add_u32 s61, s61, 8192
  s_add_u32 m0, s97, 8192
  s_nop 0
  buffer_load_dwordx4 v250, s[28:31], s61 offen lds
  s_add_u32 s61, s61, 8192
  s_add_u32 m0, s97, 65536
  s_nop 0
  buffer_load_dwordx4 v250, s[28:31], s61 offen lds
  s_add_u32 s61, s61, 8192
  s_add_u32 m0, s97, 73728
  s_nop 0
  buffer_load_dwordx4 v250, s[28:31], s61 offen lds
  s_add_u32 m0, s63, 15136
  s_add_u32 s61, s97, 12603392
  buffer_load_dwordx4 v250, s[28:31], s61 offen lds
K2_MORE:
  v_add_u32 v154, 0x200000, v154
  v_cmp_gt_u32 vcc, v158, v154
  s_cbranch_vccz K2_BIND
  v_add_u32 v155, 0x200000, v155
  v_add_u32 v156, 256, v156
  v_mov_b32 v192, -1
  v_mov_b32 v193, -1
  v_mov_b32 v194, -1
  v_mov_b32 v195, -1
  v_mov_b32 v196, -1
  v_mov_b32 v197, -1
  v_mov_b32 v198, -1
  v_mov_b32 v199, -1
  v_mov_b32 v200, -1
  v_mov_b32 v201, -1
  v_mov_b32 v202, -1
  v_mov_b32 v203, -1
  v_mov_b32 v204, -1
  v_mov_b32 v205, -1
  v_mov_b32 v206, -1
  v_mov_b32 v207, -1
  v_cmp_gt_u32 vcc, v128, v154
  v_mad_u32_u16 v208, v128, 8, v156
  s_mov_b32 s61, 0
  s_mov_b64 exec, vcc
  buffer_load_dwordx4 v[160:163], v208, s[28:31], s61 offen
  s_mov_b64 exec, -1
  v_cmp_gt_u32 vcc, v129, v154
  v_mad_u32_u16 v209, v129, 8, v156
  s_mov_b32 s61, 25088
  s_mov_b64 exec, vcc
  buffer_load_dwordx4 v[164:167], v209, s[28:31], s61 offen
  s_mov_b64 exec, -1
  v_cmp_gt_u32 vcc, v130, v154
  v_mad_u32_u16 v210, v130, 8, v156
  s_mov_b32 s61, 50176
  s_mov_b64 exec, vcc
  buffer_load_dwordx4 v[168:171], v210, s[28:31], s61 offen
  s_mov_b64 exec, -1
  v_cmp_gt_u32 vcc, v131, v154
  v_mad_u32_u16 v211, v131, 8, v156
  s_mov_b32 s61, 75264
  s_mov_b64 exec, vcc
  buffer_load_dwordx4 v[172:175], v211, s[28:31], s61 offen
  s_mov_b64 exec, -1
  v_cmp_gt_u32 vcc, v132, v154
  v_mad_u32_u16 v212, v132, 8, v156
  s_mov_b32 s61, 100352
  s_mov_b64 exec, vcc
  buffer_load_dwordx4 v[176:179], v212, s[28:31], s61 offen
  s_mov_b64 exec, -1
  v_cmp_gt_u32 vcc, v133, v154
  v_mad_u32_u16 v213, v133, 8, v156
  s_mov_b32 s61, 125440
  s_mov_b64 exec, vcc
  buffer_load_dwordx4 v[180:183], v213, s[28:31], s61 offen
  s_mov_b64 exec, -1
  v_cmp_gt_u32 vcc, v134, v154
  v_mad_u32_u16 v214, v134, 8, v156
  s_mov_b32 s61, 150528
  s_mov_b64 exec, vcc
  buffer_load_dwordx4 v[184:187], v214, s[28:31], s61 offen
  s_mov_b64 exec, -1
  v_cmp_gt_u32 vcc, v135, v154
  v_mad_u32_u16 v215, v135, 8, v156
  s_mov_b32 s61, 175616
  s_mov_b64 exec, vcc
  buffer_load_dwordx4 v[188:191], v215, s[28:31], s61 offen
  s_mov_b64 exec, -1
  s_movk_i32 s62, 2048
  s_waitcnt vmcnt(7)
  v_cmp_gt_u32 vcc, v128, v154
  v_lshrrev_b32 v208, 25, v160
  s_mov_b64 exec, vcc
  ds_add_rtn_u32 v192, v208, v157 offset:32544
  s_mov_b64 exec, -1
  v_cmp_gt_u32 vcc, v128, v155
  v_lshrrev_b32 v209, 25, v162
  s_mov_b64 exec, vcc
  ds_add_rtn_u32 v193, v209, v157 offset:32544
  s_mov_b64 exec, -1
  s_waitcnt vmcnt(6)
  v_cmp_gt_u32 vcc, v129, v154
  v_lshrrev_b32 v210, 25, v164
  s_mov_b64 exec, vcc
  ds_add_rtn_u32 v194, v210, v157 offset:32544
  s_mov_b64 exec, -1
  v_cmp_gt_u32 vcc, v129, v155
  v_lshrrev_b32 v211, 25, v166
  s_mov_b64 exec, vcc
  ds_add_rtn_u32 v195, v211, v157 offset:32544
  s_mov_b64 exec, -1
  s_waitcnt vmcnt(5)
  v_cmp_gt_u32 vcc, v130, v154
  v_lshrrev_b32 v212, 25, v168
  s_mov_b64 exec, vcc
  ds_add_rtn_u32 v196, v212, v157 offset:32544
  s_mov_b64 exec, -1
  v_cmp_gt_u32 vcc, v130, v155
  v_lshrrev_b32 v213, 25, v170
  s_mov_b64 exec, vcc
  ds_add_rtn_u32 v197, v213, v157 offset:32544
  s_mov_b64 exec, -1
  s_waitcnt vmcnt(4)
  v_cmp_gt_u32 vcc, v131, v154
  v_lshrrev_b32 v214, 25, v172
  s_mov_b64 exec, vcc
  ds_add_rtn_u32 v198, v214, v157 offset:32544
  s_mov_b64 exec, -1
  v_cmp_gt_u32 vcc, v131, v155
  v_lshrrev_b32 v215, 25, v174
  s_mov_b64 exec, vcc
  ds_add_rtn_u32 v199, v215, v157 offset:32544
  s_mov_b64 exec, -1
  s_waitcnt vmcnt(3)
  v_cmp_gt_u32 vcc, v132, v154
  v_lshrrev_b32 v216, 25, v176
  s_mov_b64 exec, vcc
  ds_add_rtn_u32 v200, v216, v157 offset:32544
  s_mov_b64 exec, -1
  v_cmp_gt_u32 vcc, v132, v155
  v_lshrrev_b32 v217, 25, v178
  s_mov_b64 exec, vcc
  ds_add_rtn_u32 v201, v217, v157 offset:32544
  s_mov_b64 exec, -1
  s_waitcnt vmcnt(2)
  v_cmp_gt_u32 vcc, v133, v154
  v_lshrrev_b32 v218, 25, v180
  s_mov_b64 exec, vcc
  ds_add_rtn_u32 v202, v218, v157 offset:32544
  s_mov_b64 exec, -1
  v_cmp_gt_u32 vcc, v133, v155
  v_lshrrev_b32 v219, 25, v182
  s_mov_b64 exec, vcc
  ds_add_rtn_u32 v203, v219, v157 offset:32544
  s_mov_b64 exec, -1
  s_waitcnt vmcnt(1)
  v_cmp_gt_u32 vcc, v134, v154
  v_lshrrev_b32 v220, 25, v184
  s_mov_b64 exec, vcc
  ds_add_rtn_u32 v204, v220, v157 offset:32544
  s_mov_b64 exec, -1
  v_cmp_gt_u32 vcc, v134, v155
  v_lshrrev_b32 v221, 25, v186
  s_mov_b64 exec, vcc
  ds_add_rtn_u32 v205, v221, v157 offset:32544
  s_mov_b64 exec, -1
  s_waitcnt vmcnt(0)
  v_cmp_gt_u32 vcc, v135, v154
  v_lshrrev_b32 v222, 25, v188
  s_mov_b64 exec, vcc
  ds_add_rtn_u32 v206, v222, v157 offset:32544
  s_mov_b64 exec, -1
  v_cmp_gt_u32 vcc, v135, v155
  v_lshrrev_b32 v223, 25, v190
  s_mov_b64 exec, vcc
  ds_add_rtn_u32 v207, v223, v157 offset:32544
  s_mov_b64 exec, -1
  s_waitcnt lgkmcnt(15)
  v_cmp_gt_u32 vcc, s62, v192
  v_lshl_add_u32 v208, v208, 12, v192
  s_mov_b64 exec, vcc
  ds_write2st64_b32 v208, v161, v160 offset0:16 offset1:26
  s_mov_b64 exec, -1
  s_waitcnt lgkmcnt(15)
  v_cmp_gt_u32 vcc, s62, v193
  v_lshl_add_u32 v209, v209, 12, v193
  s_mov_b64 exec, vcc
  ds_write2st64_b32 v209, v163, v162 offset0:16 offset1:26
  s_mov_b64 exec, -1
  s_waitcnt lgkmcnt(15)
  v_cmp_gt_u32 vcc, s62, v194
  v_lshl_add_u32 v210, v210, 12, v194
  s_mov_b64 exec, vcc
  ds_write2st64_b32 v210, v165, v164 offset0:16 offset1:26
  s_mov_b64 exec, -1
  s_waitcnt lgkmcnt(15)
  v_cmp_gt_u32 vcc, s62, v195
  v_lshl_add_u32 v211, v211, 12, v195
  s_mov_b64 exec, vcc
  ds_write2st64_b32 v211, v167, v166 offset0:16 offset1:26
  s_mov_b64 exec, -1
  s_waitcnt lgkmcnt(15)
  v_cmp_gt_u32 vcc, s62, v196
  v_lshl_add_u32 v212, v212, 12, v196
  s_mov_b64 exec, vcc
  ds_write2st64_b32 v212, v169, v168 offset0:16 offset1:26
  s_mov_b64 exec, -1
  s_waitcnt lgkmcnt(15)
  v_cmp_gt_u32 vcc, s62, v197
  v_lshl_add_u32 v213, v213, 12, v197
  s_mov_b64 exec, vcc
  ds_write2st64_b32 v213, v171, v170 offset0:16 offset1:26
  s_mov_b64 exec, -1
  s_waitcnt lgkmcnt(15)
  v_cmp_gt_u32 vcc, s62, v198
  v_lshl_add_u32 v214, v214, 12, v198
  s_mov_b64 exec, vcc
  ds_write2st64_b32 v214, v173, v172 offset0:16 offset1:26
  s_mov_b64 exec, -1
  s_waitcnt lgkmcnt(15)
  v_cmp_gt_u32 vcc, s62, v199
  v_lshl_add_u32 v215, v215, 12, v199
  s_mov_b64 exec, vcc
  ds_write2st64_b32 v215, v175, v174 offset0:16 offset1:26
  s_mov_b64 exec, -1
  s_waitcnt lgkmcnt(15)
  v_cmp_gt_u32 vcc, s62, v200
  v_lshl_add_u32 v216, v216, 12, v200
  s_mov_b64 exec, vcc
  ds_write2st64_b32 v216, v177, v176 offset0:16 offset1:26
  s_mov_b64 exec, -1
  s_waitcnt lgkmcnt(15)
  v_cmp_gt_u32 vcc, s62, v201
  v_lshl_add_u32 v217, v217, 12, v201
  s_mov_b64 exec, vcc
  ds_write2st64_b32 v217, v179, v178 offset0:16 offset1:26
  s_mov_b64 exec, -1
  s_waitcnt lgkmcnt(15)
  v_cmp_gt_u32 vcc, s62, v202
  v_lshl_add_u32 v218, v218, 12, v202
  s_mov_b64 exec, vcc
  ds_write2st64_b32 v218, v181, v180 offset0:16 offset1:26
  s_mov_b64 exec, -1
  s_waitcnt lgkmcnt(15)
  v_cmp_gt_u32 vcc, s62, v203
  v_lshl_add_u32 v219, v219, 12, v203
  s_mov_b64 exec, vcc
  ds_write2st64_b32 v219, v183, v182 offset0:16 offset1:26
  s_mov_b64 exec, -1
  s_waitcnt lgkmcnt(15)
  v_cmp_gt_u32 vcc, s62, v204
  v_lshl_add_u32 v220, v220, 12, v204
  s_mov_b64 exec, vcc
  ds_write2st64_b32 v220, v185, v184 offset0:16 offset1:26
  s_mov_b64 exec, -1
  s_waitcnt lgkmcnt(15)
  v_cmp_gt_u32 vcc, s62, v205
  v_lshl_add_u32 v221, v221, 12, v205
  s_mov_b64 exec, vcc
  ds_write2st64_b32 v221, v187, v186 offset0:16 offset1:26
  s_mov_b64 exec, -1
  s_waitcnt lgkmcnt(15)
  v_cmp_gt_u32 vcc, s62, v206
  v_lshl_add_u32 v222, v222, 12, v206
  s_mov_b64 exec, vcc
  ds_write2st64_b32 v222, v189, v188 offset0:16 offset1:26
  s_mov_b64 exec, -1
  s_waitcnt lgkmcnt(15)
  v_cmp_gt_u32 vcc, s62, v207
  v_lshl_add_u32 v223, v223, 12, v207
  s_mov_b64 exec, vcc
  ds_write2st64_b32 v223, v191, v190 offset0:16 offset1:26
  s_mov_b64 exec, -1
  s_branch K2_MORE
K2_BIND:
  v_and_b32 v249, 15, v0
  v_lshlrev_b32 v249, 2, v249
  s_waitcnt vmcnt(12) lgkmcnt(0)
  s_barrier
  ds_read_b32 v164, v249 offset:32544
  s_movk_i32 s62, 2048
  s_waitcnt lgkmcnt(0)
  v_cmp_lt_u32 vcc, s62, v164
  v_readlane_b32 s43, v164, s86
  s_cbranch_vccnz K2_SLOWM
  s_lshr_b32 s43, s43, 2
  s_mov_b32 s41, s43
  s_cmp_eq_u32 s43, 0
  s_cbranch_scc1 K2_EMPTY
  s_add_u32 s53, s43, 31
  s_lshr_b32 s53, s53, 5
  s_sub_u32 s53, s53, 1
K2_R1:
  v_lshl_add_u32 v249, v0, 2, s50
  s_lshl_b32 s61, s43, 2
  s_add_u32 s61, s61, 4096
  v_add_u32 v249, s61, v249
  v_mov_b32 v164, 0
  v_mov_b32 v165, 1638400
  ds_write2st64_b32 v249, v165, v164 offset0:0 offset1:10
  s_mov_b32 exec_hi, 0
  ds_write2st64_b32 v249, v165, v164 offset0:1 offset1:11
  s_mov_b32 exec_hi, -1
  s_add_u32 s44, s43, 31
  s_lshr_b32 s44, s44, 5
  s_mov_b32 s45, 0
  s_add_u32 s99, s44, 3
  s_lshr_b32 s99, s99, 2
  s_mov_b32 s98, s99
  s_mov_b32 s100, 0
  s_setprio 3
  v_and_b32 v255, 31, v0
  v_lshl_add_u32 v255, v255, 2, s50
  v_add_u32 v255, 4096, v255
  v_lshrrev_b32 v7, 3, v0
  v_lshl_add_u32 v7, v7, 4, s50
  v_add_u32 v7, 4224, v7
  ds_read2st64_b32 v[240:241], v255 offset0:0 offset1:10
  v_add_u32 v255, 128, v255
  ds_read2st64_b32 v[242:243], v255 offset0:0 offset1:10
  ds_read_b128 v[236:239], v7
  v_add_u32 v255, 128, v255
  v_add_u32 v7, 128, v7
  s_waitcnt lgkmcnt(2)
  v_mad_u32_u16 v182, v240, 8, 0
  s_mov_b64 exec, s[68:69]
  buffer_load_dwordx2 v[248:249], v182, s[28:31], s91 offen
  s_mov_b64 exec, -1
  v_mad_u32_u16 v220, v240, s88, v1
  v_lshl_add_u32 v224, v241, 5, v1
  buffer_load_dwordx4 v[208:211], v220, s[16:19], 0 offen offset:0
  buffer_load_dwordx4 v[212:215], v220, s[16:19], 0 offen offset:32
  buffer_load_dwordx4 v[216:219], v220, s[16:19], 0 offen offset:64
  buffer_load_dwordx4 v[220:223], v220, s[16:19], 0 offen offset:96
  buffer_load_dwordx4 v[224:227], v224, s[24:27], 0 offen
  s_cmp_eq_u32 s53, -1
  s_cbranch_scc1 K2_NOWE
  v_add_u32 v192, 16384, v250
  v_add_u32 v193, 81920, v250
  v_add_u32 v194, 147456, v250
  ds_read_b128 v[16:19], v192 offset:0
  ds_read_b128 v[20:23], v192 offset:16384
  ds_read_b128 v[24:27], v192 offset:32768
  ds_read_b128 v[28:31], v193 offset:0
  ds_read_b128 v[32:35], v193 offset:16384
  ds_read_b128 v[36:39], v193 offset:32768
  ds_read_b128 v[40:43], v193 offset:49152
  ds_read_b128 v[44:47], v194 offset:0
  ds_read_b128 v[48:51], v192 offset:1024
  ds_read_b128 v[52:55], v192 offset:17408
  ds_read_b128 v[56:59], v192 offset:33792
  ds_read_b128 v[60:63], v193 offset:1024
  ds_read_b128 v[64:67], v193 offset:17408
  ds_read_b128 v[68:71], v193 offset:33792
  ds_read_b128 v[72:75], v193 offset:50176
  ds_read_b128 v[76:79], v194 offset:1024
  ds_read_b128 v[80:83], v192 offset:2048
  ds_read_b128 v[84:87], v192 offset:18432
  ds_read_b32 v12, v192 offset:34816
  ds_read_b32 v14, v193 offset:2048
  s_waitcnt vmcnt(6)
  v_lshrrev_b32 v195, 3, v0
  v_mul_u32_u24 v195, 144, v195
  v_and_b32 v196, 7, v0
  v_lshl_add_u32 v195, v196, 4, v195
  v_add_u32 v195, s50, v195
  v_mul_u32_u24 v196, 144, v0
  v_add_u32 v196, s50, v196
  ds_write_b128 v195, v[136:139] offset:9088
  ds_write_b128 v195, v[140:143] offset:10240
  ds_write_b128 v195, v[144:147] offset:11392
  s_mov_b64 exec, 0xff
  ds_write_b128 v195, v[148:151] offset:12544
  s_mov_b64 exec, 33554431
  ds_write_b64 v196, v[152:153] offset:9216
  s_mov_b64 exec, -1
  v_lshlrev_b32 v13, 16, v13
  v_lshlrev_b32 v15, 16, v15
  s_waitcnt lgkmcnt(0)
  s_barrier
K2_NOWE:
  v_mov_b32 v184, 0
  v_mov_b32 v168, 0
  v_mov_b32 v185, 0
  v_mov_b32 v169, 0
  v_mov_b32 v186, 0
  v_mov_b32 v170, 0
  v_mov_b32 v187, 0
  v_mov_b32 v171, 0
  v_mov_b32 v188, 0
  v_mov_b32 v172, 0
  v_mov_b32 v189, 0
  v_mov_b32 v173, 0
  v_mov_b32 v190, 0
  v_mov_b32 v174, 0
  v_mov_b32 v191, 0
  v_mov_b32 v175, 0
  v_mov_b32 v0, s50
  v_mad_u32_u16 v250, v240, s89, v0 op_sel:[1,0,0,0]
  ds_read_b64 v[250:251], v250 offset:9216
  v_mad_u32_u16 v204, v240, s89, v2 op_sel:[1,0,0,0]
  ds_read_b128 v[192:195], v204 offset:9088
  ds_read_b128 v[196:199], v204 offset:9120
  ds_read_b128 v[200:203], v204 offset:9152
  ds_read_b128 v[204:207], v204 offset:9184
  v_mad_u32_u16 v6, v240, s90, v3 op_sel:[1,0,0,0]
  v_mov_b32 v176, 0x3f80
  ds_write_b16 v6, v176
  s_waitcnt vmcnt(5) lgkmcnt(5)
  v_lshlrev_b32 v176, 16, v248
  v_and_b32 v177, s60, v248
  v_lshlrev_b32 v178, 16, v249
  v_lshlrev_b32 v179, 16, v250
  v_and_b32 v180, s60, v250
  v_lshlrev_b32 v181, 16, v251
  v_sub_f32 v176, v179, v176
  v_sub_f32 v177, v180, v177
  v_sub_f32 v178, v181, v178
  v_cvt_pk_bf16_f32 v252, 0, v176
  v_cvt_pk_bf16_f32 v253, 0, v177
  v_cvt_pk_bf16_f32 v254, 0, v178
  v_mul_f32 v176, v252, v252
  v_mul_f32 v177, v253, v253
  v_mul_f32 v178, v254, v254
  v_cvt_pk_bf16_f32 v176, 0, v176
  v_cvt_pk_bf16_f32 v177, 0, v177
  v_cvt_pk_bf16_f32 v178, 0, v178
  v_add_f32 v176, v176, v177
  v_add_f32 v176, v176, v178
  v_cvt_pk_bf16_f32 v176, v176, v93
  v_cndmask_b32_e64 v92, v93, v176, s[68:69]
  v_mad_u32_u16 v182, v242, 8, 0
  s_mov_b64 exec, s[68:69]
  buffer_load_dwordx2 v[248:249], v182, s[28:31], s91 offen
  s_mov_b64 exec, -1
  s_mov_b32 m0, s93
  v_mad_u32_u16 v236, v236, s88, v228
  buffer_load_dwordx4 v236, s[16:19], 0 offen lds
  s_mov_b32 m0, s94
  v_mad_u32_u16 v237, v237, s88, v229
  buffer_load_dwordx4 v237, s[16:19], 0 offen lds
  s_mov_b32 m0, s95
  v_mad_u32_u16 v238, v238, s88, v230
  buffer_load_dwordx4 v238, s[16:19], 0 offen lds
  s_mov_b32 m0, s96
  v_mad_u32_u16 v239, v239, s88, v231
  buffer_load_dwordx4 v239, s[16:19], 0 offen lds
  v_lshl_add_u32 v244, v243, 5, v1
  buffer_load_dwordx4 v[244:247], v244, s[24:27], 0 offen
  v_mov_b32 v176, 0
  v_mov_b32 v177, 0
  v_mov_b32 v178, 0
  v_mov_b32 v179, 0
  v_mov_b32 v180, 0
  v_mov_b32 v181, 0
  v_mov_b32 v182, 0
  v_mov_b32 v183, 0
  v_mfma_f32_32x32x16_bf16 v[144:159], v[92:95], v[14:17], 0
  s_waitcnt vmcnt(6) lgkmcnt(0)
  v_mfma_f32_32x32x16_bf16 v[128:143], v[92:95], v[12:15], 0
  v_mfma_f32_32x32x16_bf16 v[128:143], v[192:195], v[16:19], v[128:143]
  v_mfma_f32_32x32x16_bf16 v[128:143], v[196:199], v[24:27], v[128:143]
  v_mfma_f32_32x32x16_bf16 v[128:143], v[200:203], v[32:35], v[128:143]
  v_mfma_f32_32x32x16_bf16 v[128:143], v[204:207], v[40:43], v[128:143]
  v_mfma_f32_32x32x16_bf16 v[128:143], v[208:211], v[48:51], v[128:143]
  v_mfma_f32_32x32x16_bf16 v[128:143], v[212:215], v[56:59], v[128:143]
  v_mfma_f32_32x32x16_bf16 v[128:143], v[216:219], v[64:67], v[128:143]
  v_mfma_f32_32x32x16_bf16 v[128:143], v[220:223], v[72:75], v[128:143]
  v_mfma_f32_32x32x16_bf16 v[128:143], v[224:227], v[80:83], v[128:143]
  s_nop 7
  s_nop 3
K2_LOOP:
  ds_read2st64_b32 v[240:241], v255 offset0:0 offset1:10
  ds_read_b128 v[236:239], v7
  v_add_u32 v255, 128, v255
  v_add_u32 v7, 128, v7
  v_mad_u32_u16 v250, v242, s89, v0 op_sel:[1,0,0,0]
  ds_read_b64 v[250:251], v250 offset:9216
  v_cvt_pk_bf16_f32 v160, v128, v129
  v_mfma_f32_32x32x16_bf16 v[112:127], v[168:171], v[184:187], v[112:127]
  v_cvt_pk_bf16_f32 v161, v130, v131
  v_cvt_pk_bf16_f32 v162, v132, v133
  v_cvt_pk_bf16_f32 v163, v134, v135
  v_cvt_pk_bf16_f32 v164, v136, v137
  v_cvt_pk_bf16_f32 v165, v138, v139
  v_cvt_pk_bf16_f32 v166, v140, v141
  v_cvt_pk_bf16_f32 v167, v142, v143
  v_or3_b32 v8, v160, v161, v162
  v_mfma_f32_32x32x16_bf16 v[112:127], v[172:175], v[188:191], v[112:127]
  v_or3_b32 v8, v8, v163, v164
  v_or3_b32 v8, v8, v165, v166
  v_or3_b32 v8, v8, v167, s54
  v_cmp_ne_u32 vcc, s54, v8
  s_waitcnt lgkmcnt(3)
  v_mfma_f32_4x4x4_16b_bf16 v[88:91], v[176:177], v[184:185], v[88:91]
  v_add_u32_sdwa v128, v160, v160 dst_sel:DWORD dst_unused:UNUSED_PAD src0_sel:WORD_0 src1_sel:WORD_0
  v_add_u32_sdwa v129, v160, v160 dst_sel:DWORD dst_unused:UNUSED_PAD src0_sel:WORD_1 src1_sel:WORD_1
  ds_read_u16_d16_hi v128, v128
  ds_read_u16_d16_hi v129, v129
  v_mfma_f32_4x4x4_16b_bf16 v[88:91], v[178:179], v[186:187], v[88:91]
  v_add_u32_sdwa v130, v161, v161 dst_sel:DWORD dst_unused:UNUSED_PAD src0_sel:WORD_0 src1_sel:WORD_0
  v_add_u32_sdwa v131, v161, v161 dst_sel:DWORD dst_unused:UNUSED_PAD src0_sel:WORD_1 src1_sel:WORD_1
  ds_read_u16_d16_hi v130, v130
  ds_read_u16_d16_hi v131, v131
  v_mfma_f32_4x4x4_16b_bf16 v[88:91], v[180:181], v[188:189], v[88:91]
  v_mfma_f32_32x32x16_bf16 v[144:159], v[192:195], v[20:23], v[144:159]
  v_add_u32_sdwa v132, v162, v162 dst_sel:DWORD dst_unused:UNUSED_PAD src0_sel:WORD_0 src1_sel:WORD_0
  v_add_u32_sdwa v133, v162, v162 dst_sel:DWORD dst_unused:UNUSED_PAD src0_sel:WORD_1 src1_sel:WORD_1
  ds_read_u16_d16_hi v132, v132
  ds_read_u16_d16_hi v133, v133
  v_mfma_f32_4x4x4_16b_bf16 v[88:91], v[182:183], v[190:191], v[88:91]
  v_add_u32_sdwa v134, v163, v163 dst_sel:DWORD dst_unused:UNUSED_PAD src0_sel:WORD_0 src1_sel:WORD_0
  v_add_u32_sdwa v135, v163, v163 dst_sel:DWORD dst_unused:UNUSED_PAD src0_sel:WORD_1 src1_sel:WORD_1
  ds_read_u16_d16_hi v134, v134
  ds_read_u16_d16_hi v135, v135
  v_add_u32_sdwa v136, v164, v164 dst_sel:DWORD dst_unused:UNUSED_PAD src0_sel:WORD_0 src1_sel:WORD_0
  v_add_u32_sdwa v137, v164, v164 dst_sel:DWORD dst_unused:UNUSED_PAD src0_sel:WORD_1 src1_sel:WORD_1
  ds_read_u16_d16_hi v136, v136
  ds_read_u16_d16_hi v137, v137
  v_mfma_f32_32x32x16_bf16 v[144:159], v[196:199], v[28:31], v[144:159]
  v_add_u32_sdwa v138, v165, v165 dst_sel:DWORD dst_unused:UNUSED_PAD src0_sel:WORD_0 src1_sel:WORD_0
  v_add_u32_sdwa v139, v165, v165 dst_sel:DWORD dst_unused:UNUSED_PAD src0_sel:WORD_1 src1_sel:WORD_1
  ds_read_u16_d16_hi v138, v138
  ds_read_u16_d16_hi v139, v139
  v_add_u32_sdwa v140, v166, v166 dst_sel:DWORD dst_unused:UNUSED_PAD src0_sel:WORD_0 src1_sel:WORD_0
  v_add_u32_sdwa v141, v166, v166 dst_sel:DWORD dst_unused:UNUSED_PAD src0_sel:WORD_1 src1_sel:WORD_1
  ds_read_u16_d16_hi v140, v140
  ds_read_u16_d16_hi v141, v141
  v_mfma_f32_32x32x16_bf16 v[144:159], v[200:203], v[36:39], v[144:159]
  v_add_u32_sdwa v142, v167, v167 dst_sel:DWORD dst_unused:UNUSED_PAD src0_sel:WORD_0 src1_sel:WORD_0
  v_add_u32_sdwa v143, v167, v167 dst_sel:DWORD dst_unused:UNUSED_PAD src0_sel:WORD_1 src1_sel:WORD_1
  ds_read_u16_d16_hi v142, v142
  ds_read_u16_d16_hi v143, v143
  s_cbranch_vccnz K2_SLOW0a
K2_BACK0a:
  s_waitcnt vmcnt(5) lgkmcnt(15)
  v_lshlrev_b32 v176, 16, v248
  v_and_b32 v177, s60, v248
  v_lshlrev_b32 v178, 16, v249
  v_lshlrev_b32 v179, 16, v250
  v_and_b32 v180, s60, v250
  v_mfma_f32_32x32x16_bf16 v[144:159], v[204:207], v[44:47], v[144:159]
  v_lshlrev_b32 v181, 16, v251
  v_sub_f32 v176, v179, v176
  v_sub_f32 v177, v180, v177
  v_sub_f32 v178, v181, v178
  v_cvt_pk_bf16_f32 v9, 0, v176
  v_cvt_pk_bf16_f32 v10, 0, v177
  v_cvt_pk_bf16_f32 v11, 0, v178
  v_mul_f32 v176, v9, v9
  v_mul_f32 v177, v10, v10
  v_mul_f32 v178, v11, v11
  v_mfma_f32_32x32x16_bf16 v[144:159], v[224:227], v[84:87], v[144:159]
  v_cvt_pk_bf16_f32 v176, 0, v176
  v_cvt_pk_bf16_f32 v177, 0, v177
  v_cvt_pk_bf16_f32 v178, 0, v178
  v_add_f32 v176, v176, v177
  v_add_f32 v176, v176, v178
  v_cvt_pk_bf16_f32 v176, v176, v93
  v_cndmask_b32_e64 v92, v93, v176, s[68:69]
  v_mad_u32_u16 v182, v240, 8, 0
  s_mov_b64 exec, s[68:69]
  buffer_load_dwordx2 v[248:249], v182, s[28:31], s91 offen
  s_mov_b64 exec, -1
  v_mfma_f32_32x32x16_bf16 v[144:159], v[208:211], v[52:55], v[144:159]
  s_waitcnt lgkmcnt(8)
  v_mul_f32 v176, v128, v13
  v_mul_f32 v177, v129, v13
  v_perm_b32 v160, v129, v128, s51
  v_mul_f32 v178, v130, v13
  v_mul_f32 v179, v131, v13
  v_perm_b32 v161, v131, v130, s51
  v_mul_f32 v180, v132, v13
  v_mul_f32 v181, v133, v13
  v_perm_b32 v162, v133, v132, s51
  v_mfma_f32_32x32x16_bf16 v[144:159], v[212:215], v[60:63], v[144:159]
  v_mul_f32 v182, v134, v13
  v_mul_f32 v183, v135, v13
  v_perm_b32 v163, v135, v134, s51
  s_waitcnt lgkmcnt(0)
  v_mad_u32_u16 v204, v242, s89, v2 op_sel:[1,0,0,0]
  ds_read_b128 v[192:195], v204 offset:9088
  ds_read_b128 v[196:199], v204 offset:9120
  ds_read_b128 v[200:203], v204 offset:9152
  ds_read_b128 v[204:207], v204 offset:9184
  v_mul_f32 v184, v136, v13
  v_mfma_f32_32x32x16_bf16 v[144:159], v[216:219], v[68:71], v[144:159]
  v_mul_f32 v185, v137, v13
  v_perm_b32 v164, v137, v136, s51
  v_mul_f32 v186, v138, v13
  v_mul_f32 v187, v139, v13
  v_perm_b32 v165, v139, v138, s51
  v_mul_f32 v188, v140, v13
  v_mul_f32 v189, v141, v13
  v_perm_b32 v166, v141, v140, s51
  v_mfma_f32_32x32x16_bf16 v[144:159], v[220:223], v[76:79], v[144:159]
  v_mul_f32 v190, v142, v13
  v_mul_f32 v191, v143, v13
  v_perm_b32 v167, v143, v142, s51
  s_cmp_ge_u32 s45, s53
  s_cbranch_scc1 K2_LAST0
  v_mfma_f32_32x32x16_bf16 v[128:143], v[92:95], v[12:15], 0
  s_nop 5
  v_cvt_pk_bf16_f32 v168, v144, v145
  v_cvt_pk_bf16_f32 v169, v146, v147
  v_cvt_pk_bf16_f32 v170, v148, v149
  v_cvt_pk_bf16_f32 v171, v150, v151
  v_cvt_pk_bf16_f32 v172, v152, v153
  v_cvt_pk_bf16_f32 v173, v154, v155
  v_cvt_pk_bf16_f32 v174, v156, v157
  v_cvt_pk_bf16_f32 v175, v158, v159
  s_waitcnt lgkmcnt(0)
  v_mfma_f32_32x32x16_bf16 v[128:143], v[192:195], v[16:19], v[128:143]
  v_or3_b32 v8, v168, v169, v170
  v_or3_b32 v8, v8, v171, v172
  v_or3_b32 v8, v8, v173, v174
  v_or3_b32 v8, v8, v175, s54
  v_cmp_ne_u32 vcc, s54, v8
  s_waitcnt vmcnt(1)
  ds_read_b128 v[208:211], v232
  ds_read_b128 v[212:215], v233
  ds_read_b128 v[216:219], v234
  ds_read_b128 v[220:223], v235
  v_add_u32_sdwa v144, v168, v168 dst_sel:DWORD dst_unused:UNUSED_PAD src0_sel:WORD_0 src1_sel:WORD_0
  v_add_u32_sdwa v145, v168, v168 dst_sel:DWORD dst_unused:UNUSED_PAD src0_sel:WORD_1 src1_sel:WORD_1
  ds_read_u16_d16_hi v144, v144
  ds_read_u16_d16_hi v145, v145
  v_mfma_f32_32x32x16_bf16 v[128:143], v[196:199], v[24:27], v[128:143]
  v_add_u32_sdwa v146, v169, v169 dst_sel:DWORD dst_unused:UNUSED_PAD src0_sel:WORD_0 src1_sel:WORD_0
  v_add_u32_sdwa v147, v169, v169 dst_sel:DWORD dst_unused:UNUSED_PAD src0_sel:WORD_1 src1_sel:WORD_1
  ds_read_u16_d16_hi v146, v146
  ds_read_u16_d16_hi v147, v147
  v_add_u32_sdwa v148, v170, v170 dst_sel:DWORD dst_unused:UNUSED_PAD src0_sel:WORD_0 src1_sel:WORD_0
  v_add_u32_sdwa v149, v170, v170 dst_sel:DWORD dst_unused:UNUSED_PAD src0_sel:WORD_1 src1_sel:WORD_1
  ds_read_u16_d16_hi v148, v148
  ds_read_u16_d16_hi v149, v149
  v_add_u32_sdwa v150, v171, v171 dst_sel:DWORD dst_unused:UNUSED_PAD src0_sel:WORD_0 src1_sel:WORD_0
  v_add_u32_sdwa v151, v171, v171 dst_sel:DWORD dst_unused:UNUSED_PAD src0_sel:WORD_1 src1_sel:WORD_1
  ds_read_u16_d16_hi v150, v150
  ds_read_u16_d16_hi v151, v151
  v_mfma_f32_32x32x16_bf16 v[128:143], v[200:203], v[32:35], v[128:143]
  v_add_u32_sdwa v152, v172, v172 dst_sel:DWORD dst_unused:UNUSED_PAD src0_sel:WORD_0 src1_sel:WORD_0
  v_add_u32_sdwa v153, v172, v172 dst_sel:DWORD dst_unused:UNUSED_PAD src0_sel:WORD_1 src1_sel:WORD_1
  ds_read_u16_d16_hi v152, v152
  ds_read_u16_d16_hi v153, v153
  v_add_u32_sdwa v154, v173, v173 dst_sel:DWORD dst_unused:UNUSED_PAD src0_sel:WORD_0 src1_sel:WORD_0
  v_add_u32_sdwa v155, v173, v173 dst_sel:DWORD dst_unused:UNUSED_PAD src0_sel:WORD_1 src1_sel:WORD_1
  ds_read_u16_d16_hi v154, v154
  ds_read_u16_d16_hi v155, v155
  v_mfma_f32_32x32x16_bf16 v[128:143], v[204:207], v[40:43], v[128:143]
  v_add_u32_sdwa v156, v174, v174 dst_sel:DWORD dst_unused:UNUSED_PAD src0_sel:WORD_0 src1_sel:WORD_0
  v_add_u32_sdwa v157, v174, v174 dst_sel:DWORD dst_unused:UNUSED_PAD src0_sel:WORD_1 src1_sel:WORD_1
  ds_read_u16_d16_hi v156, v156
  ds_read_u16_d16_hi v157, v157
  v_add_u32_sdwa v158, v175, v175 dst_sel:DWORD dst_unused:UNUSED_PAD src0_sel:WORD_0 src1_sel:WORD_0
  v_add_u32_sdwa v159, v175, v175 dst_sel:DWORD dst_unused:UNUSED_PAD src0_sel:WORD_1 src1_sel:WORD_1
  ds_read_u16_d16_hi v158, v158
  ds_read_u16_d16_hi v159, v159
  s_cbranch_vccnz K2_SLOW0b
K2_BACK0b:
  s_waitcnt lgkmcnt(15)
  s_mov_b32 m0, s93
  v_mad_u32_u16 v236, v236, s88, v228
  buffer_load_dwordx4 v236, s[16:19], 0 offen lds
  v_mfma_f32_32x32x16_bf16 v[128:143], v[244:247], v[80:83], v[128:143]
  s_mov_b32 m0, s94
  v_mad_u32_u16 v237, v237, s88, v229
  buffer_load_dwordx4 v237, s[16:19], 0 offen lds
  s_mov_b32 m0, s95
  v_mad_u32_u16 v238, v238, s88, v230
  buffer_load_dwordx4 v238, s[16:19], 0 offen lds
  s_mov_b32 m0, s96
  v_mad_u32_u16 v239, v239, s88, v231
  buffer_load_dwordx4 v239, s[16:19], 0 offen lds
  v_lshl_add_u32 v224, v241, 5, v1
  buffer_load_dwordx4 v[224:227], v224, s[24:27], 0 offen
  s_waitcnt lgkmcnt(8)
  v_fmac_f32 v176, v144, v15
  v_fmac_f32 v177, v145, v15
  v_mfma_f32_32x32x16_bf16 v[128:143], v[208:211], v[48:51], v[128:143]
  v_perm_b32 v168, v145, v144, s51
  v_fmac_f32 v178, v146, v15
  v_fmac_f32 v179, v147, v15
  v_perm_b32 v169, v147, v146, s51
  v_fmac_f32 v180, v148, v15
  v_fmac_f32 v181, v149, v15
  v_perm_b32 v170, v149, v148, s51
  v_fmac_f32 v182, v150, v15
  v_fmac_f32 v183, v151, v15
  v_perm_b32 v171, v151, v150, s51
  s_waitcnt lgkmcnt(0)
  v_fmac_f32 v184, v152, v15
  v_fmac_f32 v185, v153, v15
  v_mfma_f32_32x32x16_bf16 v[128:143], v[212:215], v[56:59], v[128:143]
  v_perm_b32 v172, v153, v152, s51
  v_fmac_f32 v186, v154, v15
  v_fmac_f32 v187, v155, v15
  v_perm_b32 v173, v155, v154, s51
  v_fmac_f32 v188, v156, v15
  v_fmac_f32 v189, v157, v15
  v_perm_b32 v174, v157, v156, s51
  v_fmac_f32 v190, v158, v15
  v_fmac_f32 v191, v159, v15
  v_perm_b32 v175, v159, v158, s51
  v_permlane16_swap_b32 v176, v184
  v_mfma_f32_32x32x16_bf16 v[128:143], v[216:219], v[64:67], v[128:143]
  v_permlane16_swap_b32 v177, v185
  v_permlane16_swap_b32 v178, v186
  v_permlane16_swap_b32 v179, v187
  v_permlane16_swap_b32 v180, v188
  v_permlane16_swap_b32 v181, v189
  v_permlane16_swap_b32 v182, v190
  v_permlane16_swap_b32 v183, v191
  v_mfma_f32_32x32x16_bf16 v[128:143], v[220:223], v[72:75], v[128:143]
  v_add_f32 v176, v176, v184
  v_add_f32 v177, v177, v185
  v_add_f32 v178, v178, v186
  v_add_f32 v179, v179, v187
  v_add_f32 v180, v180, v188
  v_add_f32 v181, v181, v189
  v_add_f32 v182, v182, v190
  v_add_f32 v183, v183, v191
  ds_read_b128 v[184:187], v4
  ds_read_b128 v[188:191], v4 offset:32
  ds_write_b16 v6, v93
  v_mad_u32_u16 v6, v242, s90, v3 op_sel:[1,0,0,0]
  v_mov_b32 v8, 0x3f80
  ds_write_b16 v6, v8
  v_mfma_f32_32x32x16_bf16 v[144:159], v[92:95], v[14:17], 0
  v_add_f32_dpp v176, v176, v176 row_mirror row_mask:0xf bank_mask:0x3
  v_add_f32_dpp v177, v177, v177 row_mirror row_mask:0xf bank_mask:0x3
  v_add_f32_dpp v178, v178, v178 row_mirror row_mask:0xf bank_mask:0x3
  v_add_f32_dpp v179, v179, v179 row_mirror row_mask:0xf bank_mask:0x3
  v_add_f32_dpp v176, v180, v180 row_mirror row_mask:0xf bank_mask:0xc
  v_add_f32_dpp v177, v181, v181 row_mirror row_mask:0xf bank_mask:0xc
  v_add_f32_dpp v178, v182, v182 row_mirror row_mask:0xf bank_mask:0xc
  v_add_f32_dpp v179, v183, v183 row_mirror row_mask:0xf bank_mask:0xc
  v_cndmask_b32_e64 v180, v176, v178, s[56:57]
  v_cndmask_b32_e64 v182, v178, v176, s[56:57]
  v_cndmask_b32_e64 v181, v177, v179, s[56:57]
  v_cndmask_b32_e64 v183, v179, v177, s[56:57]
  s_waitcnt lgkmcnt(2)
  v_mfma_f32_32x32x16_bf16 v[96:111], v[160:163], v[184:187], v[96:111]
  v_add_f32_dpp v176, v182, v180 quad_perm:[2,3,0,1] row_mask:0xf bank_mask:0xf
  v_add_f32_dpp v177, v183, v181 quad_perm:[2,3,0,1] row_mask:0xf bank_mask:0xf
  v_cndmask_b32_e64 v180, v176, v177, s[58:59]
  v_cndmask_b32_e64 v182, v177, v176, s[58:59]
  s_nop 1
  v_add_f32_dpp v176, v182, v180 quad_perm:[1,0,3,2] row_mask:0xf bank_mask:0xf
  s_nop 1
  v_add_f32_dpp v177, v176, v176 row_shl:4 row_mask:0x3 bank_mask:0x5
  s_nop 1
  v_add_f32_dpp v177, v176, v176 row_shr:4 row_mask:0xc bank_mask:0xa
  v_cvt_pk_bf16_f32 v177, 0, v177
  v_mfma_f32_32x32x16_bf16 v[96:111], v[164:167], v[188:191], v[96:111]
  v_mul_f32 v178, v252, v177
  v_mul_f32 v179, v253, v177
  v_mul_f32 v180, v254, v177
  v_cvt_pk_bf16_f32 v181, v178, v179
  v_cvt_pk_bf16_f32 v182, v180, v180
  s_mov_b64 exec, s[68:69]
  ds_write_b16 v3, v181 offset:2064
  ds_write_b16_d16_hi v3, v181 offset:2128
  ds_write_b16 v3, v182 offset:2192
  s_mov_b64 exec, -1
  ds_read_b128 v[176:179], v5
  ds_read_b128 v[180:183], v5 offset:32
  s_add_u32 s45, s45, 1
  s_cmp_ge_u32 s45, s98
  s_cbranch_scc1 K2_PRa
K2_PBa:
  s_cmp_ge_u32 s45, s44
  s_cbranch_scc1 K2_LOOPD
  ds_read2st64_b32 v[242:243], v255 offset0:0 offset1:10
  ds_read_b128 v[236:239], v7
  v_add_u32 v255, 128, v255
  v_add_u32 v7, 128, v7
  v_mad_u32_u16 v250, v240, s89, v0 op_sel:[1,0,0,0]
  ds_read_b64 v[250:251], v250 offset:9216
  v_cvt_pk_bf16_f32 v160, v128, v129
  v_mfma_f32_32x32x16_bf16 v[112:127], v[168:171], v[184:187], v[112:127]
  v_cvt_pk_bf16_f32 v161, v130, v131
  v_cvt_pk_bf16_f32 v162, v132, v133
  v_cvt_pk_bf16_f32 v163, v134, v135
  v_cvt_pk_bf16_f32 v164, v136, v137
  v_cvt_pk_bf16_f32 v165, v138, v139
  v_cvt_pk_bf16_f32 v166, v140, v141
  v_cvt_pk_bf16_f32 v167, v142, v143
  v_or3_b32 v8, v160, v161, v162
  v_mfma_f32_32x32x16_bf16 v[112:127], v[172:175], v[188:191], v[112:127]
  v_or3_b32 v8, v8, v163, v164
  v_or3_b32 v8, v8, v165, v166
  v_or3_b32 v8, v8, v167, s54
  v_cmp_ne_u32 vcc, s54, v8
  s_waitcnt lgkmcnt(3)
  v_mfma_f32_4x4x4_16b_bf16 v[88:91], v[176:177], v[184:185], v[88:91]
  v_add_u32_sdwa v128, v160, v160 dst_sel:DWORD dst_unused:UNUSED_PAD src0_sel:WORD_0 src1_sel:WORD_0
  v_add_u32_sdwa v129, v160, v160 dst_sel:DWORD dst_unused:UNUSED_PAD src0_sel:WORD_1 src1_sel:WORD_1
  ds_read_u16_d16_hi v128, v128
  ds_read_u16_d16_hi v129, v129
  v_mfma_f32_4x4x4_16b_bf16 v[88:91], v[178:179], v[186:187], v[88:91]
  v_add_u32_sdwa v130, v161, v161 dst_sel:DWORD dst_unused:UNUSED_PAD src0_sel:WORD_0 src1_sel:WORD_0
  v_add_u32_sdwa v131, v161, v161 dst_sel:DWORD dst_unused:UNUSED_PAD src0_sel:WORD_1 src1_sel:WORD_1
  ds_read_u16_d16_hi v130, v130
  ds_read_u16_d16_hi v131, v131
  v_mfma_f32_4x4x4_16b_bf16 v[88:91], v[180:181], v[188:189], v[88:91]
  v_mfma_f32_32x32x16_bf16 v[144:159], v[192:195], v[20:23], v[144:159]
  v_add_u32_sdwa v132, v162, v162 dst_sel:DWORD dst_unused:UNUSED_PAD src0_sel:WORD_0 src1_sel:WORD_0
  v_add_u32_sdwa v133, v162, v162 dst_sel:DWORD dst_unused:UNUSED_PAD src0_sel:WORD_1 src1_sel:WORD_1
  ds_read_u16_d16_hi v132, v132
  ds_read_u16_d16_hi v133, v133
  v_mfma_f32_4x4x4_16b_bf16 v[88:91], v[182:183], v[190:191], v[88:91]
  v_add_u32_sdwa v134, v163, v163 dst_sel:DWORD dst_unused:UNUSED_PAD src0_sel:WORD_0 src1_sel:WORD_0
  v_add_u32_sdwa v135, v163, v163 dst_sel:DWORD dst_unused:UNUSED_PAD src0_sel:WORD_1 src1_sel:WORD_1
  ds_read_u16_d16_hi v134, v134
  ds_read_u16_d16_hi v135, v135
  v_add_u32_sdwa v136, v164, v164 dst_sel:DWORD dst_unused:UNUSED_PAD src0_sel:WORD_0 src1_sel:WORD_0
  v_add_u32_sdwa v137, v164, v164 dst_sel:DWORD dst_unused:UNUSED_PAD src0_sel:WORD_1 src1_sel:WORD_1
  ds_read_u16_d16_hi v136, v136
  ds_read_u16_d16_hi v137, v137
  v_mfma_f32_32x32x16_bf16 v[144:159], v[196:199], v[28:31], v[144:159]
  v_add_u32_sdwa v138, v165, v165 dst_sel:DWORD dst_unused:UNUSED_PAD src0_sel:WORD_0 src1_sel:WORD_0
  v_add_u32_sdwa v139, v165, v165 dst_sel:DWORD dst_unused:UNUSED_PAD src0_sel:WORD_1 src1_sel:WORD_1
  ds_read_u16_d16_hi v138, v138
  ds_read_u16_d16_hi v139, v139
  v_add_u32_sdwa v140, v166, v166 dst_sel:DWORD dst_unused:UNUSED_PAD src0_sel:WORD_0 src1_sel:WORD_0
  v_add_u32_sdwa v141, v166, v166 dst_sel:DWORD dst_unused:UNUSED_PAD src0_sel:WORD_1 src1_sel:WORD_1
  ds_read_u16_d16_hi v140, v140
  ds_read_u16_d16_hi v141, v141
  v_mfma_f32_32x32x16_bf16 v[144:159], v[200:203], v[36:39], v[144:159]
  v_add_u32_sdwa v142, v167, v167 dst_sel:DWORD dst_unused:UNUSED_PAD src0_sel:WORD_0 src1_sel:WORD_0
  v_add_u32_sdwa v143, v167, v167 dst_sel:DWORD dst_unused:UNUSED_PAD src0_sel:WORD_1 src1_sel:WORD_1
  ds_read_u16_d16_hi v142, v142
  ds_read_u16_d16_hi v143, v143
  s_cbranch_vccnz K2_SLOW1a
K2_BACK1a:
  s_waitcnt vmcnt(5) lgkmcnt(15)
  v_lshlrev_b32 v176, 16, v248
  v_and_b32 v177, s60, v248
  v_lshlrev_b32 v178, 16, v249
  v_lshlrev_b32 v179, 16, v250
  v_and_b32 v180, s60, v250
  v_mfma_f32_32x32x16_bf16 v[144:159], v[204:207], v[44:47], v[144:159]
  v_lshlrev_b32 v181, 16, v251
  v_sub_f32 v176, v179, v176
  v_sub_f32 v177, v180, v177
  v_sub_f32 v178, v181, v178
  v_cvt_pk_bf16_f32 v252, 0, v176
  v_cvt_pk_bf16_f32 v253, 0, v177
  v_cvt_pk_bf16_f32 v254, 0, v178
  v_mul_f32 v176, v252, v252
  v_mul_f32 v177, v253, v253
  v_mul_f32 v178, v254, v254
  v_mfma_f32_32x32x16_bf16 v[144:159], v[244:247], v[84:87], v[144:159]
  v_cvt_pk_bf16_f32 v176, 0, v176
  v_cvt_pk_bf16_f32 v177, 0, v177
  v_cvt_pk_bf16_f32 v178, 0, v178
  v_add_f32 v176, v176, v177
  v_add_f32 v176, v176, v178
  v_cvt_pk_bf16_f32 v176, v176, v93
  v_cndmask_b32_e64 v92, v93, v176, s[68:69]
  v_mad_u32_u16 v182, v242, 8, 0
  s_mov_b64 exec, s[68:69]
  buffer_load_dwordx2 v[248:249], v182, s[28:31], s91 offen
  s_mov_b64 exec, -1
  v_mfma_f32_32x32x16_bf16 v[144:159], v[208:211], v[52:55], v[144:159]
  s_waitcnt lgkmcnt(8)
  v_mul_f32 v176, v128, v13
  v_mul_f32 v177, v129, v13
  v_perm_b32 v160, v129, v128, s51
  v_mul_f32 v178, v130, v13
  v_mul_f32 v179, v131, v13
  v_perm_b32 v161, v131, v130, s51
  v_mul_f32 v180, v132, v13
  v_mul_f32 v181, v133, v13
  v_perm_b32 v162, v133, v132, s51
  v_mfma_f32_32x32x16_bf16 v[144:159], v[212:215], v[60:63], v[144:159]
  v_mul_f32 v182, v134, v13
  v_mul_f32 v183, v135, v13
  v_perm_b32 v163, v135, v134, s51
  s_waitcnt lgkmcnt(0)
  v_mad_u32_u16 v204, v240, s89, v2 op_sel:[1,0,0,0]
  ds_read_b128 v[192:195], v204 offset:9088
  ds_read_b128 v[196:199], v204 offset:9120
  ds_read_b128 v[200:203], v204 offset:9152
  ds_read_b128 v[204:207], v204 offset:9184
  v_mul_f32 v184, v136, v13
  v_mfma_f32_32x32x16_bf16 v[144:159], v[216:219], v[68:71], v[144:159]
  v_mul_f32 v185, v137, v13
  v_perm_b32 v164, v137, v136, s51
  v_mul_f32 v186, v138, v13
  v_mul_f32 v187, v139, v13
  v_perm_b32 v165, v139, v138, s51
  v_mul_f32 v188, v140, v13
  v_mul_f32 v189, v141, v13
  v_perm_b32 v166, v141, v140, s51
  v_mfma_f32_32x32x16_bf16 v[144:159], v[220:223], v[76:79], v[144:159]
  v_mul_f32 v190, v142, v13
  v_mul_f32 v191, v143, v13
  v_perm_b32 v167, v143, v142, s51
  s_cmp_ge_u32 s45, s53
  s_cbranch_scc1 K2_LAST1
  v_mfma_f32_32x32x16_bf16 v[128:143], v[92:95], v[12:15], 0
  s_nop 5
  v_cvt_pk_bf16_f32 v168, v144, v145
  v_cvt_pk_bf16_f32 v169, v146, v147
  v_cvt_pk_bf16_f32 v170, v148, v149
  v_cvt_pk_bf16_f32 v171, v150, v151
  v_cvt_pk_bf16_f32 v172, v152, v153
  v_cvt_pk_bf16_f32 v173, v154, v155
  v_cvt_pk_bf16_f32 v174, v156, v157
  v_cvt_pk_bf16_f32 v175, v158, v159
  s_waitcnt lgkmcnt(0)
  v_mfma_f32_32x32x16_bf16 v[128:143], v[192:195], v[16:19], v[128:143]
  v_or3_b32 v8, v168, v169, v170
  v_or3_b32 v8, v8, v171, v172
  v_or3_b32 v8, v8, v173, v174
  v_or3_b32 v8, v8, v175, s54
  v_cmp_ne_u32 vcc, s54, v8
  s_waitcnt vmcnt(1)
  ds_read_b128 v[208:211], v232
  ds_read_b128 v[212:215], v233
  ds_read_b128 v[216:219], v234
  ds_read_b128 v[220:223], v235
  v_add_u32_sdwa v144, v168, v168 dst_sel:DWORD dst_unused:UNUSED_PAD src0_sel:WORD_0 src1_sel:WORD_0
  v_add_u32_sdwa v145, v168, v168 dst_sel:DWORD dst_unused:UNUSED_PAD src0_sel:WORD_1 src1_sel:WORD_1
  ds_read_u16_d16_hi v144, v144
  ds_read_u16_d16_hi v145, v145
  v_mfma_f32_32x32x16_bf16 v[128:143], v[196:199], v[24:27], v[128:143]
  v_add_u32_sdwa v146, v169, v169 dst_sel:DWORD dst_unused:UNUSED_PAD src0_sel:WORD_0 src1_sel:WORD_0
  v_add_u32_sdwa v147, v169, v169 dst_sel:DWORD dst_unused:UNUSED_PAD src0_sel:WORD_1 src1_sel:WORD_1
  ds_read_u16_d16_hi v146, v146
  ds_read_u16_d16_hi v147, v147
  v_add_u32_sdwa v148, v170, v170 dst_sel:DWORD dst_unused:UNUSED_PAD src0_sel:WORD_0 src1_sel:WORD_0
  v_add_u32_sdwa v149, v170, v170 dst_sel:DWORD dst_unused:UNUSED_PAD src0_sel:WORD_1 src1_sel:WORD_1
  ds_read_u16_d16_hi v148, v148
  ds_read_u16_d16_hi v149, v149
  v_add_u32_sdwa v150, v171, v171 dst_sel:DWORD dst_unused:UNUSED_PAD src0_sel:WORD_0 src1_sel:WORD_0
  v_add_u32_sdwa v151, v171, v171 dst_sel:DWORD dst_unused:UNUSED_PAD src0_sel:WORD_1 src1_sel:WORD_1
  ds_read_u16_d16_hi v150, v150
  ds_read_u16_d16_hi v151, v151
  v_mfma_f32_32x32x16_bf16 v[128:143], v[200:203], v[32:35], v[128:143]
  v_add_u32_sdwa v152, v172, v172 dst_sel:DWORD dst_unused:UNUSED_PAD src0_sel:WORD_0 src1_sel:WORD_0
  v_add_u32_sdwa v153, v172, v172 dst_sel:DWORD dst_unused:UNUSED_PAD src0_sel:WORD_1 src1_sel:WORD_1
  ds_read_u16_d16_hi v152, v152
  ds_read_u16_d16_hi v153, v153
  v_add_u32_sdwa v154, v173, v173 dst_sel:DWORD dst_unused:UNUSED_PAD src0_sel:WORD_0 src1_sel:WORD_0
  v_add_u32_sdwa v155, v173, v173 dst_sel:DWORD dst_unused:UNUSED_PAD src0_sel:WORD_1 src1_sel:WORD_1
  ds_read_u16_d16_hi v154, v154
  ds_read_u16_d16_hi v155, v155
  v_mfma_f32_32x32x16_bf16 v[128:143], v[204:207], v[40:43], v[128:143]
  v_add_u32_sdwa v156, v174, v174 dst_sel:DWORD dst_unused:UNUSED_PAD src0_sel:WORD_0 src1_sel:WORD_0
  v_add_u32_sdwa v157, v174, v174 dst_sel:DWORD dst_unused:UNUSED_PAD src0_sel:WORD_1 src1_sel:WORD_1
  ds_read_u16_d16_hi v156, v156
  ds_read_u16_d16_hi v157, v157
  v_add_u32_sdwa v158, v175, v175 dst_sel:DWORD dst_unused:UNUSED_PAD src0_sel:WORD_0 src1_sel:WORD_0
  v_add_u32_sdwa v159, v175, v175 dst_sel:DWORD dst_unused:UNUSED_PAD src0_sel:WORD_1 src1_sel:WORD_1
  ds_read_u16_d16_hi v158, v158
  ds_read_u16_d16_hi v159, v159
  s_cbranch_vccnz K2_SLOW1b
K2_BACK1b:
  s_waitcnt lgkmcnt(15)
  s_mov_b32 m0, s93
  v_mad_u32_u16 v236, v236, s88, v228
  buffer_load_dwordx4 v236, s[16:19], 0 offen lds
  v_mfma_f32_32x32x16_bf16 v[128:143], v[224:227], v[80:83], v[128:143]
  s_mov_b32 m0, s94
  v_mad_u32_u16 v237, v237, s88, v229
  buffer_load_dwordx4 v237, s[16:19], 0 offen lds
  s_mov_b32 m0, s95
  v_mad_u32_u16 v238, v238, s88, v230
  buffer_load_dwordx4 v238, s[16:19], 0 offen lds
  s_mov_b32 m0, s96
  v_mad_u32_u16 v239, v239, s88, v231
  buffer_load_dwordx4 v239, s[16:19], 0 offen lds
  v_lshl_add_u32 v244, v243, 5, v1
  buffer_load_dwordx4 v[244:247], v244, s[24:27], 0 offen
  s_waitcnt lgkmcnt(8)
  v_fmac_f32 v176, v144, v15
  v_fmac_f32 v177, v145, v15
  v_mfma_f32_32x32x16_bf16 v[128:143], v[208:211], v[48:51], v[128:143]
  v_perm_b32 v168, v145, v144, s51
  v_fmac_f32 v178, v146, v15
  v_fmac_f32 v179, v147, v15
  v_perm_b32 v169, v147, v146, s51
  v_fmac_f32 v180, v148, v15
  v_fmac_f32 v181, v149, v15
  v_perm_b32 v170, v149, v148, s51
  v_fmac_f32 v182, v150, v15
  v_fmac_f32 v183, v151, v15
  v_perm_b32 v171, v151, v150, s51
  s_waitcnt lgkmcnt(0)
  v_fmac_f32 v184, v152, v15
  v_fmac_f32 v185, v153, v15
  v_mfma_f32_32x32x16_bf16 v[128:143], v[212:215], v[56:59], v[128:143]
  v_perm_b32 v172, v153, v152, s51
  v_fmac_f32 v186, v154, v15
  v_fmac_f32 v187, v155, v15
  v_perm_b32 v173, v155, v154, s51
  v_fmac_f32 v188, v156, v15
  v_fmac_f32 v189, v157, v15
  v_perm_b32 v174, v157, v156, s51
  v_fmac_f32 v190, v158, v15
  v_fmac_f32 v191, v159, v15
  v_perm_b32 v175, v159, v158, s51
  v_permlane16_swap_b32 v176, v184
  v_mfma_f32_32x32x16_bf16 v[128:143], v[216:219], v[64:67], v[128:143]
  v_permlane16_swap_b32 v177, v185
  v_permlane16_swap_b32 v178, v186
  v_permlane16_swap_b32 v179, v187
  v_permlane16_swap_b32 v180, v188
  v_permlane16_swap_b32 v181, v189
  v_permlane16_swap_b32 v182, v190
  v_permlane16_swap_b32 v183, v191
  v_mfma_f32_32x32x16_bf16 v[128:143], v[220:223], v[72:75], v[128:143]
  v_add_f32 v176, v176, v184
  v_add_f32 v177, v177, v185
  v_add_f32 v178, v178, v186
  v_add_f32 v179, v179, v187
  v_add_f32 v180, v180, v188
  v_add_f32 v181, v181, v189
  v_add_f32 v182, v182, v190
  v_add_f32 v183, v183, v191
  ds_read_b128 v[184:187], v4
  ds_read_b128 v[188:191], v4 offset:32
  ds_write_b16 v6, v93
  v_mad_u32_u16 v6, v240, s90, v3 op_sel:[1,0,0,0]
  v_mov_b32 v8, 0x3f80
  ds_write_b16 v6, v8
  v_mfma_f32_32x32x16_bf16 v[144:159], v[92:95], v[14:17], 0
  v_add_f32_dpp v176, v176, v176 row_mirror row_mask:0xf bank_mask:0x3
  v_add_f32_dpp v177, v177, v177 row_mirror row_mask:0xf bank_mask:0x3
  v_add_f32_dpp v178, v178, v178 row_mirror row_mask:0xf bank_mask:0x3
  v_add_f32_dpp v179, v179, v179 row_mirror row_mask:0xf bank_mask:0x3
  v_add_f32_dpp v176, v180, v180 row_mirror row_mask:0xf bank_mask:0xc
  v_add_f32_dpp v177, v181, v181 row_mirror row_mask:0xf bank_mask:0xc
  v_add_f32_dpp v178, v182, v182 row_mirror row_mask:0xf bank_mask:0xc
  v_add_f32_dpp v179, v183, v183 row_mirror row_mask:0xf bank_mask:0xc
  v_cndmask_b32_e64 v180, v176, v178, s[56:57]
  v_cndmask_b32_e64 v182, v178, v176, s[56:57]
  v_cndmask_b32_e64 v181, v177, v179, s[56:57]
  v_cndmask_b32_e64 v183, v179, v177, s[56:57]
  s_waitcnt lgkmcnt(2)
  v_mfma_f32_32x32x16_bf16 v[96:111], v[160:163], v[184:187], v[96:111]
  v_add_f32_dpp v176, v182, v180 quad_perm:[2,3,0,1] row_mask:0xf bank_mask:0xf
  v_add_f32_dpp v177, v183, v181 quad_perm:[2,3,0,1] row_mask:0xf bank_mask:0xf
  v_cndmask_b32_e64 v180, v176, v177, s[58:59]
  v_cndmask_b32_e64 v182, v177, v176, s[58:59]
  s_nop 1
  v_add_f32_dpp v176, v182, v180 quad_perm:[1,0,3,2] row_mask:0xf bank_mask:0xf
  s_nop 1
  v_add_f32_dpp v177, v176, v176 row_shl:4 row_mask:0x3 bank_mask:0x5
  s_nop 1
  v_add_f32_dpp v177, v176, v176 row_shr:4 row_mask:0xc bank_mask:0xa
  v_cvt_pk_bf16_f32 v177, 0, v177
  v_mfma_f32_32x32x16_bf16 v[96:111], v[164:167], v[188:191], v[96:111]
  v_mul_f32 v178, v9, v177
  v_mul_f32 v179, v10, v177
  v_mul_f32 v180, v11, v177
  v_cvt_pk_bf16_f32 v181, v178, v179
  v_cvt_pk_bf16_f32 v182, v180, v180
  s_mov_b64 exec, s[68:69]
  ds_write_b16 v3, v181 offset:2064
  ds_write_b16_d16_hi v3, v181 offset:2128
  ds_write_b16 v3, v182 offset:2192
  s_mov_b64 exec, -1
  ds_read_b128 v[176:179], v5
  ds_read_b128 v[180:183], v5 offset:32
  s_add_u32 s45, s45, 1
  s_cmp_ge_u32 s45, s98
  s_cbranch_scc1 K2_PRb
K2_PBb:
  s_cmp_lt_u32 s45, s44
  s_cbranch_scc1 K2_LOOP
K2_LOOPD:
  s_waitcnt lgkmcnt(0)
  v_mfma_f32_32x32x16_bf16 v[112:127], v[168:171], v[184:187], v[112:127]
  v_mfma_f32_32x32x16_bf16 v[112:127], v[172:175], v[188:191], v[112:127]
  v_mfma_f32_4x4x4_16b_bf16 v[88:91], v[176:177], v[184:185], v[88:91]
  s_nop 1
  v_mfma_f32_4x4x4_16b_bf16 v[88:91], v[178:179], v[186:187], v[88:91]
  s_nop 1
  v_mfma_f32_4x4x4_16b_bf16 v[88:91], v[180:181], v[188:189], v[88:91]
  s_nop 1
  v_mfma_f32_4x4x4_16b_bf16 v[88:91], v[182:183], v[190:191], v[88:91]
  ds_write_b16 v6, v93
  v_mbcnt_lo_u32_b32 v0, -1, 0
  v_mbcnt_hi_u32_b32 v0, -1, v0
  s_waitcnt vmcnt(0)
  s_branch K2_SROUND
K2_EMPTY:
  s_waitcnt vmcnt(0)
  v_lshrrev_b32 v195, 3, v0
  v_mul_u32_u24 v195, 144, v195
  v_and_b32 v196, 7, v0
  v_lshl_add_u32 v195, v196, 4, v195
  v_add_u32 v195, s50, v195
  v_mul_u32_u24 v196, 144, v0
  v_add_u32 v196, s50, v196
  ds_write_b128 v195, v[136:139] offset:9088
  ds_write_b128 v195, v[140:143] offset:10240
  ds_write_b128 v195, v[144:147] offset:11392
  s_mov_b64 exec, 0xff
  ds_write_b128 v195, v[148:151] offset:12544
  s_mov_b64 exec, 33554431
  ds_write_b64 v196, v[152:153] offset:9216
  s_mov_b64 exec, -1
  v_lshlrev_b32 v13, 16, v13
  v_lshlrev_b32 v15, 16, v15
  s_waitcnt lgkmcnt(0)
  s_barrier
  s_branch K2_EPI
K2_SLOWM:
  v_add_u32 v192, 16384, v250
  v_add_u32 v193, 81920, v250
  v_add_u32 v194, 147456, v250
  ds_read_b128 v[16:19], v192 offset:0
  ds_read_b128 v[20:23], v192 offset:16384
  ds_read_b128 v[24:27], v192 offset:32768
  ds_read_b128 v[28:31], v193 offset:0
  ds_read_b128 v[32:35], v193 offset:16384
  ds_read_b128 v[36:39], v193 offset:32768
  ds_read_b128 v[40:43], v193 offset:49152
  ds_read_b128 v[44:47], v194 offset:0
  ds_read_b128 v[48:51], v192 offset:1024
  ds_read_b128 v[52:55], v192 offset:17408
  ds_read_b128 v[56:59], v192 offset:33792
  ds_read_b128 v[60:63], v193 offset:1024
  ds_read_b128 v[64:67], v193 offset:17408
  ds_read_b128 v[68:71], v193 offset:33792
  ds_read_b128 v[72:75], v193 offset:50176
  ds_read_b128 v[76:79], v194 offset:1024
  ds_read_b128 v[80:83], v192 offset:2048
  ds_read_b128 v[84:87], v192 offset:18432
  ds_read_b32 v12, v192 offset:34816
  ds_read_b32 v14, v193 offset:2048
  s_waitcnt vmcnt(0)
  v_lshrrev_b32 v195, 3, v0
  v_mul_u32_u24 v195, 144, v195
  v_and_b32 v196, 7, v0
  v_lshl_add_u32 v195, v196, 4, v195
  v_add_u32 v195, s50, v195
  v_mul_u32_u24 v196, 144, v0
  v_add_u32 v196, s50, v196
  ds_write_b128 v195, v[136:139] offset:9088
  ds_write_b128 v195, v[140:143] offset:10240
  ds_write_b128 v195, v[144:147] offset:11392
  s_mov_b64 exec, 0xff
  ds_write_b128 v195, v[148:151] offset:12544
  s_mov_b64 exec, 33554431
  ds_write_b64 v196, v[152:153] offset:9216
  s_mov_b64 exec, -1
  v_lshlrev_b32 v13, 16, v13
  v_lshlrev_b32 v15, 16, v15
  s_mov_b32 s87, 0
  s_mov_b32 s101, 0
  s_mov_b32 s53, -1
  s_mov_b32 s41, 0
K2_SROUND:
  s_waitcnt lgkmcnt(0)
  s_barrier
  v_and_b32 v249, 15, v0
  v_lshlrev_b32 v249, 2, v249
  v_mov_b32 v164, 0
  v_mov_b32 v157, 4
  v_mov_b32 v192, -1
  ds_write_b32 v249, v164 offset:32544
  s_waitcnt lgkmcnt(0)
  s_barrier
  s_cmp_ge_u32 s87, 32
  s_cbranch_scc1 K2_SR2
  s_lshl_b32 s61, s87, 2
  s_add_u32 s61, s61, s3
  buffer_load_dword v165, v164, s[28:31], s61 offen
  s_mov_b64 exec, 1
  ds_add_u32 v164, v157 offset:32544
  s_mov_b64 exec, -1
  s_waitcnt vmcnt(0)
  v_readfirstlane_b32 s62, v165
  s_and_b32 s61, s62, 0xffff
  s_lshr_b32 s63, s62, 16
  s_mul_i32 s62, s87, 3136
  s_add_u32 s61, s61, s62
  s_add_u32 s61, s61, s64
  v_add_u32 v166, s101, v0
  v_add_u32 v167, s61, v166
  v_lshlrev_b32 v167, 3, v167
  v_cmp_gt_u32 vcc, s63, v166
  s_mov_b64 exec, vcc
  buffer_load_dwordx2 v[160:161], v167, s[28:31], 0 offen
  s_mov_b64 exec, -1
  s_add_u32 s101, s101, 64
  s_cmp_lt_u32 s101, s63
  s_cbranch_scc1 K2_SR1
  s_mov_b32 s101, 0
  s_add_u32 s87, s87, 1
K2_SR1:
  s_movk_i32 s62, 2048
  s_waitcnt vmcnt(0)
  v_lshrrev_b32 v208, 25, v160
  s_mov_b64 exec, vcc
  ds_add_rtn_u32 v192, v208, v157 offset:32544
  s_mov_b64 exec, -1
  s_waitcnt lgkmcnt(0)
  v_cmp_gt_u32 vcc, s62, v192
  v_lshl_add_u32 v208, v208, 12, v192
  s_mov_b64 exec, vcc
  ds_write2st64_b32 v208, v161, v160 offset0:16 offset1:26
  s_mov_b64 exec, -1
K2_SR2:
  s_waitcnt lgkmcnt(0)
  s_barrier
  ds_read_b32 v164, v249 offset:32544
  s_waitcnt lgkmcnt(0)
  v_readlane_b32 s61, v164, 0
  v_readlane_b32 s43, v164, s86
  s_cmp_eq_u32 s61, 0
  s_cbranch_scc1 K2_EPI
  s_lshr_b32 s43, s43, 2
  s_cmp_eq_u32 s43, 0
  s_cbranch_scc1 K2_SROUND
  s_branch K2_R1
K2_LAST0:
  s_waitcnt lgkmcnt(0)
  v_mbcnt_lo_u32_b32 v0, -1, 0
  v_mbcnt_hi_u32_b32 v0, -1, v0
  v_lshlrev_b32 v250, 4, v0
  s_mov_b32 s61, 12611584
  s_mov_b32 s62, 12615680
  buffer_load_dwordx4 v[48:51], v250, s[28:31], s61 offen offset:0
  buffer_load_dwordx4 v[56:59], v250, s[28:31], s61 offen offset:2048
  buffer_load_dwordx4 v[64:67], v250, s[28:31], s62 offen offset:0
  buffer_load_dwordx4 v[72:75], v250, s[28:31], s62 offen offset:2048
  buffer_load_dwordx4 v[52:55], v250, s[28:31], s61 offen offset:1024
  buffer_load_dwordx4 v[60:63], v250, s[28:31], s61 offen offset:3072
  buffer_load_dwordx4 v[68:71], v250, s[28:31], s62 offen offset:1024
  buffer_load_dwordx4 v[76:79], v250, s[28:31], s62 offen offset:3072
  v_cvt_pk_bf16_f32 v168, v144, v145
  v_cvt_pk_bf16_f32 v169, v146, v147
  v_cvt_pk_bf16_f32 v170, v148, v149
  v_cvt_pk_bf16_f32 v171, v150, v151
  v_cvt_pk_bf16_f32 v172, v152, v153
  v_cvt_pk_bf16_f32 v173, v154, v155
  v_cvt_pk_bf16_f32 v174, v156, v157
  v_cvt_pk_bf16_f32 v175, v158, v159
  v_or3_b32 v8, v168, v169, v170
  v_or3_b32 v8, v8, v171, v172
  v_or3_b32 v8, v8, v173, v174
  v_or3_b32 v8, v8, v175, s54
  v_cmp_ne_u32 vcc, s54, v8
  v_add_u32_sdwa v144, v168, v168 dst_sel:DWORD dst_unused:UNUSED_PAD src0_sel:WORD_0 src1_sel:WORD_0
  v_add_u32_sdwa v145, v168, v168 dst_sel:DWORD dst_unused:UNUSED_PAD src0_sel:WORD_1 src1_sel:WORD_1
  ds_read_u16_d16_hi v144, v144
  ds_read_u16_d16_hi v145, v145
  v_add_u32 v9, 16384, v250
  v_add_u32_sdwa v146, v169, v169 dst_sel:DWORD dst_unused:UNUSED_PAD src0_sel:WORD_0 src1_sel:WORD_0
  v_add_u32_sdwa v147, v169, v169 dst_sel:DWORD dst_unused:UNUSED_PAD src0_sel:WORD_1 src1_sel:WORD_1
  ds_read_u16_d16_hi v146, v146
  ds_read_u16_d16_hi v147, v147
  v_add_u32 v10, 81920, v250
  v_add_u32_sdwa v148, v170, v170 dst_sel:DWORD dst_unused:UNUSED_PAD src0_sel:WORD_0 src1_sel:WORD_0
  v_add_u32_sdwa v149, v170, v170 dst_sel:DWORD dst_unused:UNUSED_PAD src0_sel:WORD_1 src1_sel:WORD_1
  ds_read_u16_d16_hi v148, v148
  ds_read_u16_d16_hi v149, v149
  v_add_u32 v11, 147456, v250
  v_add_u32_sdwa v150, v171, v171 dst_sel:DWORD dst_unused:UNUSED_PAD src0_sel:WORD_0 src1_sel:WORD_0
  v_add_u32_sdwa v151, v171, v171 dst_sel:DWORD dst_unused:UNUSED_PAD src0_sel:WORD_1 src1_sel:WORD_1
  ds_read_u16_d16_hi v150, v150
  ds_read_u16_d16_hi v151, v151
  v_and_b32 v7, 31, v0
  v_add_u32_sdwa v152, v172, v172 dst_sel:DWORD dst_unused:UNUSED_PAD src0_sel:WORD_0 src1_sel:WORD_0
  v_add_u32_sdwa v153, v172, v172 dst_sel:DWORD dst_unused:UNUSED_PAD src0_sel:WORD_1 src1_sel:WORD_1
  ds_read_u16_d16_hi v152, v152
  ds_read_u16_d16_hi v153, v153
  v_min_u32 v6, 25, v7
  v_add_u32_sdwa v154, v173, v173 dst_sel:DWORD dst_unused:UNUSED_PAD src0_sel:WORD_0 src1_sel:WORD_0
  v_add_u32_sdwa v155, v173, v173 dst_sel:DWORD dst_unused:UNUSED_PAD src0_sel:WORD_1 src1_sel:WORD_1
  ds_read_u16_d16_hi v154, v154
  ds_read_u16_d16_hi v155, v155
  v_mul_u32_u24 v6, 144, v6
  v_add_u32_sdwa v156, v174, v174 dst_sel:DWORD dst_unused:UNUSED_PAD src0_sel:WORD_0 src1_sel:WORD_0
  v_add_u32_sdwa v157, v174, v174 dst_sel:DWORD dst_unused:UNUSED_PAD src0_sel:WORD_1 src1_sel:WORD_1
  ds_read_u16_d16_hi v156, v156
  ds_read_u16_d16_hi v157, v157
  v_add_u32 v251, v6, v2
  v_add_u32_sdwa v158, v175, v175 dst_sel:DWORD dst_unused:UNUSED_PAD src0_sel:WORD_0 src1_sel:WORD_0
  v_add_u32_sdwa v159, v175, v175 dst_sel:DWORD dst_unused:UNUSED_PAD src0_sel:WORD_1 src1_sel:WORD_1
  ds_read_u16_d16_hi v158, v158
  ds_read_u16_d16_hi v159, v159
  v_add_u32 v255, s40, v7
  ds_read_b128 v[16:19], v9 offset:15136
  ds_read_b128 v[24:27], v9 offset:47904
  ds_read_b128 v[32:35], v10 offset:31520
  ds_read_b128 v[40:43], v10 offset:64288
  ds_read_b128 v[192:195], v251 offset:9088
  ds_read_b128 v[196:199], v251 offset:9120
  ds_read_b128 v[200:203], v251 offset:9152
  ds_read_b128 v[204:207], v251 offset:9184
  ds_read_b128 v[208:211], v4
  ds_read_b128 v[212:215], v4 offset:32
  ds_read_b128 v[20:23], v9 offset:31520
  ds_read_b128 v[28:31], v10 offset:15136
  ds_read_b128 v[36:39], v10 offset:47904
  ds_read_b128 v[44:47], v11 offset:15136
  s_cbranch_vccnz K2_SLOW0c
K2_BACK0c:
  v_lshrrev_b32 v4, 1, v1
  v_add3_u32 v6, v6, v4, s50
  v_lshl_add_u32 v4, v255, 7, v4
  v_cmp_gt_u32 s[66:67], s42, v7
  s_waitcnt lgkmcnt(14)
  v_fmac_f32 v176, v144, v15
  v_fmac_f32 v177, v145, v15
  v_perm_b32 v168, v145, v144, s51
  v_fmac_f32 v178, v146, v15
  v_fmac_f32 v179, v147, v15
  v_perm_b32 v169, v147, v146, s51
  v_fmac_f32 v180, v148, v15
  v_fmac_f32 v181, v149, v15
  v_perm_b32 v170, v149, v148, s51
  v_fmac_f32 v182, v150, v15
  v_fmac_f32 v183, v151, v15
  v_perm_b32 v171, v151, v150, s51
  s_waitcnt lgkmcnt(6)
  v_mfma_f32_32x32x16_bf16 v[128:143], v[16:19], v[192:195], 0
  v_fmac_f32 v184, v152, v15
  v_fmac_f32 v185, v153, v15
  v_perm_b32 v172, v153, v152, s51
  v_fmac_f32 v186, v154, v15
  v_fmac_f32 v187, v155, v15
  v_mfma_f32_32x32x16_bf16 v[128:143], v[24:27], v[196:199], v[128:143]
  v_perm_b32 v173, v155, v154, s51
  v_fmac_f32 v188, v156, v15
  v_fmac_f32 v189, v157, v15
  v_perm_b32 v174, v157, v156, s51
  v_fmac_f32 v190, v158, v15
  v_fmac_f32 v191, v159, v15
  v_perm_b32 v175, v159, v158, s51
  s_waitcnt lgkmcnt(4)
  v_mfma_f32_32x32x16_bf16 v[96:111], v[160:163], v[208:211], v[96:111]
  v_permlane16_swap_b32 v176, v184
  v_permlane16_swap_b32 v177, v185
  v_permlane16_swap_b32 v178, v186
  v_mfma_f32_32x32x16_bf16 v[96:111], v[164:167], v[212:215], v[96:111]
  v_permlane16_swap_b32 v179, v187
  v_permlane16_swap_b32 v180, v188
  v_permlane16_swap_b32 v181, v189
  v_mfma_f32_32x32x16_bf16 v[112:127], v[168:171], v[208:211], v[112:127]
  v_permlane16_swap_b32 v182, v190
  v_permlane16_swap_b32 v183, v191
  v_add_f32 v176, v176, v184
  v_add_f32 v177, v177, v185
  v_add_f32 v178, v178, v186
  v_mfma_f32_32x32x16_bf16 v[112:127], v[172:175], v[212:215], v[112:127]
  v_add_f32 v179, v179, v187
  v_add_f32 v180, v180, v188
  v_add_f32 v181, v181, v189
  v_add_f32 v182, v182, v190
  v_add_f32 v183, v183, v191
  v_add_f32_dpp v176, v176, v176 row_mirror row_mask:0xf bank_mask:0x3
  v_add_f32_dpp v177, v177, v177 row_mirror row_mask:0xf bank_mask:0x3
  v_add_f32_dpp v178, v178, v178 row_mirror row_mask:0xf bank_mask:0x3
  v_mfma_f32_32x32x16_bf16 v[128:143], v[32:35], v[200:203], v[128:143]
  v_add_f32_dpp v179, v179, v179 row_mirror row_mask:0xf bank_mask:0x3
  v_cvt_pk_bf16_f32 v160, v96, v97
  v_cvt_pk_bf16_f32 v161, v98, v99
  v_cvt_pk_bf16_f32 v162, v100, v101
  v_cvt_pk_bf16_f32 v163, v102, v103
  v_cvt_pk_bf16_f32 v164, v104, v105
  v_cvt_pk_bf16_f32 v165, v106, v107
  v_mfma_f32_32x32x16_bf16 v[128:143], v[40:43], v[204:207], v[128:143]
  v_cvt_pk_bf16_f32 v166, v108, v109
  v_cvt_pk_bf16_f32 v167, v110, v111
  v_add_f32_dpp v176, v180, v180 row_mirror row_mask:0xf bank_mask:0xc
  v_add_f32_dpp v177, v181, v181 row_mirror row_mask:0xf bank_mask:0xc
  v_add_f32_dpp v178, v182, v182 row_mirror row_mask:0xf bank_mask:0xc
  v_add_f32_dpp v179, v183, v183 row_mirror row_mask:0xf bank_mask:0xc
  v_cndmask_b32_e64 v180, v176, v178, s[56:57]
  s_waitcnt vmcnt(4)
  v_mfma_f32_32x32x16_bf16 v[128:143], v[48:51], v[160:163], v[128:143]
  v_cndmask_b32_e64 v182, v178, v176, s[56:57]
  v_cndmask_b32_e64 v181, v177, v179, s[56:57]
  v_cndmask_b32_e64 v183, v179, v177, s[56:57]
  v_cvt_pk_bf16_f32 v168, v112, v113
  v_cvt_pk_bf16_f32 v169, v114, v115
  v_add_f32_dpp v176, v182, v180 quad_perm:[2,3,0,1] row_mask:0xf bank_mask:0xf
  v_add_f32_dpp v177, v183, v181 quad_perm:[2,3,0,1] row_mask:0xf bank_mask:0xf
  v_mfma_f32_32x32x16_bf16 v[128:143], v[56:59], v[164:167], v[128:143]
  v_cndmask_b32_e64 v180, v176, v177, s[58:59]
  v_cndmask_b32_e64 v182, v177, v176, s[58:59]
  v_cvt_pk_bf16_f32 v170, v116, v117
  v_cvt_pk_bf16_f32 v171, v118, v119
  v_add_f32_dpp v176, v182, v180 quad_perm:[1,0,3,2] row_mask:0xf bank_mask:0xf
  v_cvt_pk_bf16_f32 v172, v120, v121
  v_cvt_pk_bf16_f32 v173, v122, v123
  v_add_f32_dpp v177, v176, v176 row_shl:4 row_mask:0x3 bank_mask:0x5
  v_cvt_pk_bf16_f32 v174, v124, v125
  v_cvt_pk_bf16_f32 v175, v126, v127
  v_add_f32_dpp v177, v176, v176 row_shr:4 row_mask:0xc bank_mask:0xa
  v_mfma_f32_32x32x16_bf16 v[128:143], v[64:67], v[168:171], v[128:143]
  v_cvt_pk_bf16_f32 v177, 0, v177
  v_mul_f32 v178, v252, v177
  v_mul_f32 v179, v253, v177
  v_mul_f32 v180, v254, v177
  v_cvt_pk_bf16_f32 v181, v178, v179
  v_cvt_pk_bf16_f32 v182, v180, v180
  v_mfma_f32_32x32x16_bf16 v[128:143], v[72:75], v[172:175], v[128:143]
  s_mov_b64 exec, s[68:69]
  ds_write_b16 v3, v181 offset:2064
  ds_write_b16_d16_hi v3, v181 offset:2128
  ds_write_b16 v3, v182 offset:2192
  s_mov_b64 exec, -1
  ds_read_b128 v[216:219], v5
  ds_read_b128 v[220:223], v5 offset:32
  s_waitcnt lgkmcnt(5)
  v_mfma_f32_32x32x16_bf16 v[144:159], v[20:23], v[192:195], 0
  ds_read_b64 v[228:229], v6 offset:9088
  ds_read_b64 v[230:231], v6 offset:9104
  ds_read_b64 v[232:233], v6 offset:9120
  ds_read_b64 v[234:235], v6 offset:9136
  ds_read_b64 v[236:237], v6 offset:9152
  ds_read_b64 v[238:239], v6 offset:9168
  ds_read_b64 v[240:241], v6 offset:9184
  ds_read_b64 v[242:243], v6 offset:9200
  ds_read_b64 v[250:251], v6 offset:9216
  v_mul_u32_u24 v5, 6, v255
  v_cvt_pk_bf16_f32 v96, v128, v129
  v_mfma_f32_32x32x16_bf16 v[144:159], v[28:31], v[196:199], v[144:159]
  v_cvt_pk_bf16_f32 v97, v130, v131
  v_cvt_pk_bf16_f32 v98, v132, v133
  v_cvt_pk_bf16_f32 v99, v134, v135
  v_cvt_pk_bf16_f32 v100, v136, v137
  v_cvt_pk_bf16_f32 v101, v138, v139
  v_cvt_pk_bf16_f32 v102, v140, v141
  v_cvt_pk_bf16_f32 v103, v142, v143
  v_or3_b32 v8, v96, v97, v98
  v_mfma_f32_32x32x16_bf16 v[144:159], v[36:39], v[200:203], v[144:159]
  v_or3_b32 v8, v8, v99, v100
  v_or3_b32 v8, v8, v101, v102
  v_or3_b32 v8, v8, v103, s54
  v_cmp_ne_u32 vcc, s54, v8
  s_waitcnt vmcnt(0) lgkmcnt(0)
  v_mfma_f32_32x32x16_bf16 v[144:159], v[44:47], v[204:207], v[144:159]
  v_add_u32_sdwa v128, v96, v96 dst_sel:DWORD dst_unused:UNUSED_PAD src0_sel:WORD_0 src1_sel:WORD_0
  v_add_u32_sdwa v129, v96, v96 dst_sel:DWORD dst_unused:UNUSED_PAD src0_sel:WORD_1 src1_sel:WORD_1
  ds_read_u16_d16_hi v128, v128
  ds_read_u16_d16_hi v129, v129
  v_mfma_f32_4x4x4_16b_bf16 v[88:91], v[216:217], v[208:209], v[88:91]
  v_add_u32_sdwa v130, v97, v97 dst_sel:DWORD dst_unused:UNUSED_PAD src0_sel:WORD_0 src1_sel:WORD_0
  v_add_u32_sdwa v131, v97, v97 dst_sel:DWORD dst_unused:UNUSED_PAD src0_sel:WORD_1 src1_sel:WORD_1
  ds_read_u16_d16_hi v130, v130
  ds_read_u16_d16_hi v131, v131
  v_mfma_f32_32x32x16_bf16 v[144:159], v[52:55], v[160:163], v[144:159]
  v_add_u32_sdwa v132, v98, v98 dst_sel:DWORD dst_unused:UNUSED_PAD src0_sel:WORD_0 src1_sel:WORD_0
  v_add_u32_sdwa v133, v98, v98 dst_sel:DWORD dst_unused:UNUSED_PAD src0_sel:WORD_1 src1_sel:WORD_1
  ds_read_u16_d16_hi v132, v132
  ds_read_u16_d16_hi v133, v133
  v_mfma_f32_4x4x4_16b_bf16 v[88:91], v[218:219], v[210:211], v[88:91]
  v_add_u32_sdwa v134, v99, v99 dst_sel:DWORD dst_unused:UNUSED_PAD src0_sel:WORD_0 src1_sel:WORD_0
  v_add_u32_sdwa v135, v99, v99 dst_sel:DWORD dst_unused:UNUSED_PAD src0_sel:WORD_1 src1_sel:WORD_1
  ds_read_u16_d16_hi v134, v134
  ds_read_u16_d16_hi v135, v135
  v_mfma_f32_32x32x16_bf16 v[144:159], v[60:63], v[164:167], v[144:159]
  v_add_u32_sdwa v136, v100, v100 dst_sel:DWORD dst_unused:UNUSED_PAD src0_sel:WORD_0 src1_sel:WORD_0
  v_add_u32_sdwa v137, v100, v100 dst_sel:DWORD dst_unused:UNUSED_PAD src0_sel:WORD_1 src1_sel:WORD_1
  ds_read_u16_d16_hi v136, v136
  ds_read_u16_d16_hi v137, v137
  v_mfma_f32_32x32x16_bf16 v[144:159], v[68:71], v[168:171], v[144:159]
  v_add_u32_sdwa v138, v101, v101 dst_sel:DWORD dst_unused:UNUSED_PAD src0_sel:WORD_0 src1_sel:WORD_0
  v_add_u32_sdwa v139, v101, v101 dst_sel:DWORD dst_unused:UNUSED_PAD src0_sel:WORD_1 src1_sel:WORD_1
  ds_read_u16_d16_hi v138, v138
  ds_read_u16_d16_hi v139, v139
  v_mfma_f32_4x4x4_16b_bf16 v[88:91], v[220:221], v[212:213], v[88:91]
  v_add_u32_sdwa v140, v102, v102 dst_sel:DWORD dst_unused:UNUSED_PAD src0_sel:WORD_0 src1_sel:WORD_0
  v_add_u32_sdwa v141, v102, v102 dst_sel:DWORD dst_unused:UNUSED_PAD src0_sel:WORD_1 src1_sel:WORD_1
  ds_read_u16_d16_hi v140, v140
  ds_read_u16_d16_hi v141, v141
  v_mfma_f32_32x32x16_bf16 v[144:159], v[76:79], v[172:175], v[144:159]
  v_add_u32_sdwa v142, v103, v103 dst_sel:DWORD dst_unused:UNUSED_PAD src0_sel:WORD_0 src1_sel:WORD_0
  v_add_u32_sdwa v143, v103, v103 dst_sel:DWORD dst_unused:UNUSED_PAD src0_sel:WORD_1 src1_sel:WORD_1
  ds_read_u16_d16_hi v142, v142
  ds_read_u16_d16_hi v143, v143
  v_mfma_f32_4x4x4_16b_bf16 v[88:91], v[222:223], v[214:215], v[88:91]
  s_cbranch_vccnz K2_SLOW0ce0
K2_BACK0ce0:
  v_lshlrev_b32 v180, 16, v250
  v_and_b32 v181, s60, v250
  v_lshlrev_b32 v182, 16, v251
  s_waitcnt lgkmcnt(8)
  v_lshlrev_b32 v244, 16, v228
  v_and_b32 v245, s60, v228
  v_add_f32 v128, v128, v244
  v_add_f32 v129, v129, v245
  v_cvt_pk_bf16_f32 v96, v128, v129
  v_lshlrev_b32 v246, 16, v229
  v_and_b32 v247, s60, v229
  v_add_f32 v130, v130, v246
  v_add_f32 v131, v131, v247
  v_cvt_pk_bf16_f32 v97, v130, v131
  v_cvt_pk_bf16_f32 v104, v144, v145
  v_cvt_pk_bf16_f32 v105, v146, v147
  v_cvt_pk_bf16_f32 v106, v148, v149
  v_cvt_pk_bf16_f32 v107, v150, v151
  v_cvt_pk_bf16_f32 v108, v152, v153
  v_cvt_pk_bf16_f32 v109, v154, v155
  v_cvt_pk_bf16_f32 v110, v156, v157
  v_cvt_pk_bf16_f32 v111, v158, v159
  v_or3_b32 v8, v104, v105, v106
  v_or3_b32 v8, v8, v107, v108
  v_or3_b32 v8, v8, v109, v110
  v_or3_b32 v8, v8, v111, s54
  v_cmp_ne_u32 vcc, s54, v8
  v_add_u32_sdwa v144, v104, v104 dst_sel:DWORD dst_unused:UNUSED_PAD src0_sel:WORD_0 src1_sel:WORD_0
  v_add_u32_sdwa v145, v104, v104 dst_sel:DWORD dst_unused:UNUSED_PAD src0_sel:WORD_1 src1_sel:WORD_1
  ds_read_u16_d16_hi v144, v144
  ds_read_u16_d16_hi v145, v145
  v_add_u32_sdwa v146, v105, v105 dst_sel:DWORD dst_unused:UNUSED_PAD src0_sel:WORD_0 src1_sel:WORD_0
  v_add_u32_sdwa v147, v105, v105 dst_sel:DWORD dst_unused:UNUSED_PAD src0_sel:WORD_1 src1_sel:WORD_1
  ds_read_u16_d16_hi v146, v146
  ds_read_u16_d16_hi v147, v147
  v_add_u32_sdwa v148, v106, v106 dst_sel:DWORD dst_unused:UNUSED_PAD src0_sel:WORD_0 src1_sel:WORD_0
  v_add_u32_sdwa v149, v106, v106 dst_sel:DWORD dst_unused:UNUSED_PAD src0_sel:WORD_1 src1_sel:WORD_1
  ds_read_u16_d16_hi v148, v148
  ds_read_u16_d16_hi v149, v149
  v_add_u32_sdwa v150, v107, v107 dst_sel:DWORD dst_unused:UNUSED_PAD src0_sel:WORD_0 src1_sel:WORD_0
  v_add_u32_sdwa v151, v107, v107 dst_sel:DWORD dst_unused:UNUSED_PAD src0_sel:WORD_1 src1_sel:WORD_1
  ds_read_u16_d16_hi v150, v150
  ds_read_u16_d16_hi v151, v151
  s_waitcnt lgkmcnt(8)
  v_add_u32_sdwa v152, v108, v108 dst_sel:DWORD dst_unused:UNUSED_PAD src0_sel:WORD_0 src1_sel:WORD_0
  v_add_u32_sdwa v153, v108, v108 dst_sel:DWORD dst_unused:UNUSED_PAD src0_sel:WORD_1 src1_sel:WORD_1
  ds_read_u16_d16_hi v152, v152
  ds_read_u16_d16_hi v153, v153
  v_add_u32_sdwa v154, v109, v109 dst_sel:DWORD dst_unused:UNUSED_PAD src0_sel:WORD_0 src1_sel:WORD_0
  v_add_u32_sdwa v155, v109, v109 dst_sel:DWORD dst_unused:UNUSED_PAD src0_sel:WORD_1 src1_sel:WORD_1
  ds_read_u16_d16_hi v154, v154
  ds_read_u16_d16_hi v155, v155
  v_add_u32_sdwa v156, v110, v110 dst_sel:DWORD dst_unused:UNUSED_PAD src0_sel:WORD_0 src1_sel:WORD_0
  v_add_u32_sdwa v157, v110, v110 dst_sel:DWORD dst_unused:UNUSED_PAD src0_sel:WORD_1 src1_sel:WORD_1
  ds_read_u16_d16_hi v156, v156
  ds_read_u16_d16_hi v157, v157
  v_add_u32_sdwa v158, v111, v111 dst_sel:DWORD dst_unused:UNUSED_PAD src0_sel:WORD_0 src1_sel:WORD_0
  v_add_u32_sdwa v159, v111, v111 dst_sel:DWORD dst_unused:UNUSED_PAD src0_sel:WORD_1 src1_sel:WORD_1
  ds_read_u16_d16_hi v158, v158
  ds_read_u16_d16_hi v159, v159
  v_lshlrev_b32 v244, 16, v230
  v_and_b32 v245, s60, v230
  v_add_f32 v132, v132, v244
  v_add_f32 v133, v133, v245
  v_cvt_pk_bf16_f32 v98, v132, v133
  v_lshlrev_b32 v246, 16, v231
  v_and_b32 v247, s60, v231
  v_add_f32 v134, v134, v246
  v_add_f32 v135, v135, v247
  v_cvt_pk_bf16_f32 v99, v134, v135
  s_mov_b64 exec, s[66:67]
  buffer_store_dwordx2 v[96:97], v4, s[32:35], 0 offen offset:0
  buffer_store_dwordx2 v[98:99], v4, s[32:35], 0 offen offset:16
  s_mov_b64 exec, -1
  v_lshlrev_b32 v244, 16, v232
  v_and_b32 v245, s60, v232
  v_add_f32 v136, v136, v244
  v_add_f32 v137, v137, v245
  v_cvt_pk_bf16_f32 v100, v136, v137
  v_lshlrev_b32 v246, 16, v233
  v_and_b32 v247, s60, v233
  v_add_f32 v138, v138, v246
  v_add_f32 v139, v139, v247
  v_cvt_pk_bf16_f32 v101, v138, v139
  v_lshlrev_b32 v244, 16, v234
  v_and_b32 v245, s60, v234
  v_add_f32 v140, v140, v244
  v_add_f32 v141, v141, v245
  v_cvt_pk_bf16_f32 v102, v140, v141
  v_lshlrev_b32 v246, 16, v235
  v_and_b32 v247, s60, v235
  v_add_f32 v142, v142, v246
  v_add_f32 v143, v143, v247
  v_cvt_pk_bf16_f32 v103, v142, v143
  s_mov_b64 exec, s[66:67]
  buffer_store_dwordx2 v[100:101], v4, s[32:35], 0 offen offset:32
  buffer_store_dwordx2 v[102:103], v4, s[32:35], 0 offen offset:48
  s_mov_b64 exec, -1
  s_cbranch_vccnz K2_SLOW0ce1
K2_BACK0ce1:
  s_waitcnt lgkmcnt(0)
  v_lshlrev_b32 v244, 16, v236
  v_and_b32 v245, s60, v236
  v_add_f32 v144, v144, v244
  v_add_f32 v145, v145, v245
  v_cvt_pk_bf16_f32 v104, v144, v145
  v_lshlrev_b32 v246, 16, v237
  v_and_b32 v247, s60, v237
  v_add_f32 v146, v146, v246
  v_add_f32 v147, v147, v247
  v_cvt_pk_bf16_f32 v105, v146, v147
  v_lshlrev_b32 v244, 16, v238
  v_and_b32 v245, s60, v238
  v_add_f32 v148, v148, v244
  v_add_f32 v149, v149, v245
  v_cvt_pk_bf16_f32 v106, v148, v149
  v_lshlrev_b32 v246, 16, v239
  v_and_b32 v247, s60, v239
  v_add_f32 v150, v150, v246
  v_add_f32 v151, v151, v247
  v_cvt_pk_bf16_f32 v107, v150, v151
  s_mov_b64 exec, s[66:67]
  buffer_store_dwordx2 v[104:105], v4, s[32:35], 0 offen offset:64
  buffer_store_dwordx2 v[106:107], v4, s[32:35], 0 offen offset:80
  s_mov_b64 exec, -1
  v_lshlrev_b32 v244, 16, v240
  v_and_b32 v245, s60, v240
  v_add_f32 v152, v152, v244
  v_add_f32 v153, v153, v245
  v_cvt_pk_bf16_f32 v108, v152, v153
  v_lshlrev_b32 v246, 16, v241
  v_and_b32 v247, s60, v241
  v_add_f32 v154, v154, v246
  v_add_f32 v155, v155, v247
  v_cvt_pk_bf16_f32 v109, v154, v155
  v_lshlrev_b32 v244, 16, v242
  v_and_b32 v245, s60, v242
  v_add_f32 v156, v156, v244
  v_add_f32 v157, v157, v245
  v_cvt_pk_bf16_f32 v110, v156, v157
  v_lshlrev_b32 v246, 16, v243
  v_and_b32 v247, s60, v243
  v_add_f32 v158, v158, v246
  v_add_f32 v159, v159, v247
  v_cvt_pk_bf16_f32 v111, v158, v159
  s_mov_b64 exec, s[66:67]
  buffer_store_dwordx2 v[108:109], v4, s[32:35], 0 offen offset:96
  buffer_store_dwordx2 v[110:111], v4, s[32:35], 0 offen offset:112
  s_mov_b64 exec, -1
  v_mov_b32 v176, v88
  v_mov_b32 v177, v89
  v_mov_b32 v178, v90
  v_permlane32_swap_b32 v176, v88
  v_permlane32_swap_b32 v177, v89
  v_permlane32_swap_b32 v178, v90
  v_add_f32 v176, v176, v88
  v_add_f32 v177, v177, v89
  v_add_f32 v178, v178, v90
  v_cvt_pk_bf16_f32 v176, 0, v176
  v_cvt_pk_bf16_f32 v177, 0, v177
  v_cvt_pk_bf16_f32 v178, 0, v178
  v_add_f32 v176, v176, v180
  v_add_f32 v177, v177, v181
  v_add_f32 v178, v178, v182
  v_cvt_pk_bf16_f32 v176, v176, v176
  v_cvt_pk_bf16_f32 v177, v177, v177
  v_cvt_pk_bf16_f32 v178, v178, v178
  s_mov_b32 exec_lo, s66
  s_mov_b32 exec_hi, 0
  s_mov_b32 s61, 6400000
  buffer_store_short v176, v5, s[32:35], s61 offen offset:0
  buffer_store_short v177, v5, s[32:35], s61 offen offset:2
  buffer_store_short v178, v5, s[32:35], s61 offen offset:4
  s_endpgm
K2_LAST1:
  s_waitcnt lgkmcnt(0)
  v_mbcnt_lo_u32_b32 v0, -1, 0
  v_mbcnt_hi_u32_b32 v0, -1, v0
  v_lshlrev_b32 v250, 4, v0
  s_mov_b32 s61, 12611584
  s_mov_b32 s62, 12615680
  buffer_load_dwordx4 v[48:51], v250, s[28:31], s61 offen offset:0
  buffer_load_dwordx4 v[56:59], v250, s[28:31], s61 offen offset:2048
  buffer_load_dwordx4 v[64:67], v250, s[28:31], s62 offen offset:0
  buffer_load_dwordx4 v[72:75], v250, s[28:31], s62 offen offset:2048
  buffer_load_dwordx4 v[52:55], v250, s[28:31], s61 offen offset:1024
  buffer_load_dwordx4 v[60:63], v250, s[28:31], s61 offen offset:3072
  buffer_load_dwordx4 v[68:71], v250, s[28:31], s62 offen offset:1024
  buffer_load_dwordx4 v[76:79], v250, s[28:31], s62 offen offset:3072
  v_cvt_pk_bf16_f32 v168, v144, v145
  v_cvt_pk_bf16_f32 v169, v146, v147
  v_cvt_pk_bf16_f32 v170, v148, v149
  v_cvt_pk_bf16_f32 v171, v150, v151
  v_cvt_pk_bf16_f32 v172, v152, v153
  v_cvt_pk_bf16_f32 v173, v154, v155
  v_cvt_pk_bf16_f32 v174, v156, v157
  v_cvt_pk_bf16_f32 v175, v158, v159
  v_or3_b32 v8, v168, v169, v170
  v_or3_b32 v8, v8, v171, v172
  v_or3_b32 v8, v8, v173, v174
  v_or3_b32 v8, v8, v175, s54
  v_cmp_ne_u32 vcc, s54, v8
  v_add_u32_sdwa v144, v168, v168 dst_sel:DWORD dst_unused:UNUSED_PAD src0_sel:WORD_0 src1_sel:WORD_0
  v_add_u32_sdwa v145, v168, v168 dst_sel:DWORD dst_unused:UNUSED_PAD src0_sel:WORD_1 src1_sel:WORD_1
  ds_read_u16_d16_hi v144, v144
  ds_read_u16_d16_hi v145, v145
  v_add_u32 v252, 16384, v250
  v_add_u32_sdwa v146, v169, v169 dst_sel:DWORD dst_unused:UNUSED_PAD src0_sel:WORD_0 src1_sel:WORD_0
  v_add_u32_sdwa v147, v169, v169 dst_sel:DWORD dst_unused:UNUSED_PAD src0_sel:WORD_1 src1_sel:WORD_1
  ds_read_u16_d16_hi v146, v146
  ds_read_u16_d16_hi v147, v147
  v_add_u32 v253, 81920, v250
  v_add_u32_sdwa v148, v170, v170 dst_sel:DWORD dst_unused:UNUSED_PAD src0_sel:WORD_0 src1_sel:WORD_0
  v_add_u32_sdwa v149, v170, v170 dst_sel:DWORD dst_unused:UNUSED_PAD src0_sel:WORD_1 src1_sel:WORD_1
  ds_read_u16_d16_hi v148, v148
  ds_read_u16_d16_hi v149, v149
  v_add_u32 v254, 147456, v250
  v_add_u32_sdwa v150, v171, v171 dst_sel:DWORD dst_unused:UNUSED_PAD src0_sel:WORD_0 src1_sel:WORD_0
  v_add_u32_sdwa v151, v171, v171 dst_sel:DWORD dst_unused:UNUSED_PAD src0_sel:WORD_1 src1_sel:WORD_1
  ds_read_u16_d16_hi v150, v150
  ds_read_u16_d16_hi v151, v151
  v_and_b32 v7, 31, v0
  v_add_u32_sdwa v152, v172, v172 dst_sel:DWORD dst_unused:UNUSED_PAD src0_sel:WORD_0 src1_sel:WORD_0
  v_add_u32_sdwa v153, v172, v172 dst_sel:DWORD dst_unused:UNUSED_PAD src0_sel:WORD_1 src1_sel:WORD_1
  ds_read_u16_d16_hi v152, v152
  ds_read_u16_d16_hi v153, v153
  v_min_u32 v6, 25, v7
  v_add_u32_sdwa v154, v173, v173 dst_sel:DWORD dst_unused:UNUSED_PAD src0_sel:WORD_0 src1_sel:WORD_0
  v_add_u32_sdwa v155, v173, v173 dst_sel:DWORD dst_unused:UNUSED_PAD src0_sel:WORD_1 src1_sel:WORD_1
  ds_read_u16_d16_hi v154, v154
  ds_read_u16_d16_hi v155, v155
  v_mul_u32_u24 v6, 144, v6
  v_add_u32_sdwa v156, v174, v174 dst_sel:DWORD dst_unused:UNUSED_PAD src0_sel:WORD_0 src1_sel:WORD_0
  v_add_u32_sdwa v157, v174, v174 dst_sel:DWORD dst_unused:UNUSED_PAD src0_sel:WORD_1 src1_sel:WORD_1
  ds_read_u16_d16_hi v156, v156
  ds_read_u16_d16_hi v157, v157
  v_add_u32 v251, v6, v2
  v_add_u32_sdwa v158, v175, v175 dst_sel:DWORD dst_unused:UNUSED_PAD src0_sel:WORD_0 src1_sel:WORD_0
  v_add_u32_sdwa v159, v175, v175 dst_sel:DWORD dst_unused:UNUSED_PAD src0_sel:WORD_1 src1_sel:WORD_1
  ds_read_u16_d16_hi v158, v158
  ds_read_u16_d16_hi v159, v159
  v_add_u32 v255, s40, v7
  ds_read_b128 v[16:19], v252 offset:15136
  ds_read_b128 v[24:27], v252 offset:47904
  ds_read_b128 v[32:35], v253 offset:31520
  ds_read_b128 v[40:43], v253 offset:64288
  ds_read_b128 v[192:195], v251 offset:9088
  ds_read_b128 v[196:199], v251 offset:9120
  ds_read_b128 v[200:203], v251 offset:9152
  ds_read_b128 v[204:207], v251 offset:9184
  ds_read_b128 v[208:211], v4
  ds_read_b128 v[212:215], v4 offset:32
  ds_read_b128 v[20:23], v252 offset:31520
  ds_read_b128 v[28:31], v253 offset:15136
  ds_read_b128 v[36:39], v253 offset:47904
  ds_read_b128 v[44:47], v254 offset:15136
  s_cbranch_vccnz K2_SLOW1c
K2_BACK1c:
  v_lshrrev_b32 v4, 1, v1
  v_add3_u32 v6, v6, v4, s50
  v_lshl_add_u32 v4, v255, 7, v4
  v_cmp_gt_u32 s[66:67], s42, v7
  s_waitcnt lgkmcnt(14)
  v_fmac_f32 v176, v144, v15
  v_fmac_f32 v177, v145, v15
  v_perm_b32 v168, v145, v144, s51
  v_fmac_f32 v178, v146, v15
  v_fmac_f32 v179, v147, v15
  v_perm_b32 v169, v147, v146, s51
  v_fmac_f32 v180, v148, v15
  v_fmac_f32 v181, v149, v15
  v_perm_b32 v170, v149, v148, s51
  v_fmac_f32 v182, v150, v15
  v_fmac_f32 v183, v151, v15
  v_perm_b32 v171, v151, v150, s51
  s_waitcnt lgkmcnt(6)
  v_mfma_f32_32x32x16_bf16 v[128:143], v[16:19], v[192:195], 0
  v_fmac_f32 v184, v152, v15
  v_fmac_f32 v185, v153, v15
  v_perm_b32 v172, v153, v152, s51
  v_fmac_f32 v186, v154, v15
  v_fmac_f32 v187, v155, v15
  v_mfma_f32_32x32x16_bf16 v[128:143], v[24:27], v[196:199], v[128:143]
  v_perm_b32 v173, v155, v154, s51
  v_fmac_f32 v188, v156, v15
  v_fmac_f32 v189, v157, v15
  v_perm_b32 v174, v157, v156, s51
  v_fmac_f32 v190, v158, v15
  v_fmac_f32 v191, v159, v15
  v_perm_b32 v175, v159, v158, s51
  s_waitcnt lgkmcnt(4)
  v_mfma_f32_32x32x16_bf16 v[96:111], v[160:163], v[208:211], v[96:111]
  v_permlane16_swap_b32 v176, v184
  v_permlane16_swap_b32 v177, v185
  v_permlane16_swap_b32 v178, v186
  v_mfma_f32_32x32x16_bf16 v[96:111], v[164:167], v[212:215], v[96:111]
  v_permlane16_swap_b32 v179, v187
  v_permlane16_swap_b32 v180, v188
  v_permlane16_swap_b32 v181, v189
  v_mfma_f32_32x32x16_bf16 v[112:127], v[168:171], v[208:211], v[112:127]
  v_permlane16_swap_b32 v182, v190
  v_permlane16_swap_b32 v183, v191
  v_add_f32 v176, v176, v184
  v_add_f32 v177, v177, v185
  v_add_f32 v178, v178, v186
  v_mfma_f32_32x32x16_bf16 v[112:127], v[172:175], v[212:215], v[112:127]
  v_add_f32 v179, v179, v187
  v_add_f32 v180, v180, v188
  v_add_f32 v181, v181, v189
  v_add_f32 v182, v182, v190
  v_add_f32 v183, v183, v191
  v_add_f32_dpp v176, v176, v176 row_mirror row_mask:0xf bank_mask:0x3
  v_add_f32_dpp v177, v177, v177 row_mirror row_mask:0xf bank_mask:0x3
  v_add_f32_dpp v178, v178, v178 row_mirror row_mask:0xf bank_mask:0x3
  v_mfma_f32_32x32x16_bf16 v[128:143], v[32:35], v[200:203], v[128:143]
  v_add_f32_dpp v179, v179, v179 row_mirror row_mask:0xf bank_mask:0x3
  v_cvt_pk_bf16_f32 v160, v96, v97
  v_cvt_pk_bf16_f32 v161, v98, v99
  v_cvt_pk_bf16_f32 v162, v100, v101
  v_cvt_pk_bf16_f32 v163, v102, v103
  v_cvt_pk_bf16_f32 v164, v104, v105
  v_cvt_pk_bf16_f32 v165, v106, v107
  v_mfma_f32_32x32x16_bf16 v[128:143], v[40:43], v[204:207], v[128:143]
  v_cvt_pk_bf16_f32 v166, v108, v109
  v_cvt_pk_bf16_f32 v167, v110, v111
  v_add_f32_dpp v176, v180, v180 row_mirror row_mask:0xf bank_mask:0xc
  v_add_f32_dpp v177, v181, v181 row_mirror row_mask:0xf bank_mask:0xc
  v_add_f32_dpp v178, v182, v182 row_mirror row_mask:0xf bank_mask:0xc
  v_add_f32_dpp v179, v183, v183 row_mirror row_mask:0xf bank_mask:0xc
  v_cndmask_b32_e64 v180, v176, v178, s[56:57]
  s_waitcnt vmcnt(4)
  v_mfma_f32_32x32x16_bf16 v[128:143], v[48:51], v[160:163], v[128:143]
  v_cndmask_b32_e64 v182, v178, v176, s[56:57]
  v_cndmask_b32_e64 v181, v177, v179, s[56:57]
  v_cndmask_b32_e64 v183, v179, v177, s[56:57]
  v_cvt_pk_bf16_f32 v168, v112, v113
  v_cvt_pk_bf16_f32 v169, v114, v115
  v_add_f32_dpp v176, v182, v180 quad_perm:[2,3,0,1] row_mask:0xf bank_mask:0xf
  v_add_f32_dpp v177, v183, v181 quad_perm:[2,3,0,1] row_mask:0xf bank_mask:0xf
  v_mfma_f32_32x32x16_bf16 v[128:143], v[56:59], v[164:167], v[128:143]
  v_cndmask_b32_e64 v180, v176, v177, s[58:59]
  v_cndmask_b32_e64 v182, v177, v176, s[58:59]
  v_cvt_pk_bf16_f32 v170, v116, v117
  v_cvt_pk_bf16_f32 v171, v118, v119
  v_add_f32_dpp v176, v182, v180 quad_perm:[1,0,3,2] row_mask:0xf bank_mask:0xf
  v_cvt_pk_bf16_f32 v172, v120, v121
  v_cvt_pk_bf16_f32 v173, v122, v123
  v_add_f32_dpp v177, v176, v176 row_shl:4 row_mask:0x3 bank_mask:0x5
  v_cvt_pk_bf16_f32 v174, v124, v125
  v_cvt_pk_bf16_f32 v175, v126, v127
  v_add_f32_dpp v177, v176, v176 row_shr:4 row_mask:0xc bank_mask:0xa
  v_mfma_f32_32x32x16_bf16 v[128:143], v[64:67], v[168:171], v[128:143]
  v_cvt_pk_bf16_f32 v177, 0, v177
  v_mul_f32 v178, v9, v177
  v_mul_f32 v179, v10, v177
  v_mul_f32 v180, v11, v177
  v_cvt_pk_bf16_f32 v181, v178, v179
  v_cvt_pk_bf16_f32 v182, v180, v180
  v_mfma_f32_32x32x16_bf16 v[128:143], v[72:75], v[172:175], v[128:143]
  s_mov_b64 exec, s[68:69]
  ds_write_b16 v3, v181 offset:2064
  ds_write_b16_d16_hi v3, v181 offset:2128
  ds_write_b16 v3, v182 offset:2192
  s_mov_b64 exec, -1
  ds_read_b128 v[216:219], v5
  ds_read_b128 v[220:223], v5 offset:32
  s_waitcnt lgkmcnt(5)
  v_mfma_f32_32x32x16_bf16 v[144:159], v[20:23], v[192:195], 0
  ds_read_b64 v[228:229], v6 offset:9088
  ds_read_b64 v[230:231], v6 offset:9104
  ds_read_b64 v[232:233], v6 offset:9120
  ds_read_b64 v[234:235], v6 offset:9136
  ds_read_b64 v[236:237], v6 offset:9152
  ds_read_b64 v[238:239], v6 offset:9168
  ds_read_b64 v[240:241], v6 offset:9184
  ds_read_b64 v[242:243], v6 offset:9200
  ds_read_b64 v[250:251], v6 offset:9216
  v_mul_u32_u24 v5, 6, v255
  v_cvt_pk_bf16_f32 v96, v128, v129
  v_mfma_f32_32x32x16_bf16 v[144:159], v[28:31], v[196:199], v[144:159]
  v_cvt_pk_bf16_f32 v97, v130, v131
  v_cvt_pk_bf16_f32 v98, v132, v133
  v_cvt_pk_bf16_f32 v99, v134, v135
  v_cvt_pk_bf16_f32 v100, v136, v137
  v_cvt_pk_bf16_f32 v101, v138, v139
  v_cvt_pk_bf16_f32 v102, v140, v141
  v_cvt_pk_bf16_f32 v103, v142, v143
  v_or3_b32 v8, v96, v97, v98
  v_mfma_f32_32x32x16_bf16 v[144:159], v[36:39], v[200:203], v[144:159]
  v_or3_b32 v8, v8, v99, v100
  v_or3_b32 v8, v8, v101, v102
  v_or3_b32 v8, v8, v103, s54
  v_cmp_ne_u32 vcc, s54, v8
  s_waitcnt vmcnt(0) lgkmcnt(0)
  v_mfma_f32_32x32x16_bf16 v[144:159], v[44:47], v[204:207], v[144:159]
  v_add_u32_sdwa v128, v96, v96 dst_sel:DWORD dst_unused:UNUSED_PAD src0_sel:WORD_0 src1_sel:WORD_0
  v_add_u32_sdwa v129, v96, v96 dst_sel:DWORD dst_unused:UNUSED_PAD src0_sel:WORD_1 src1_sel:WORD_1
  ds_read_u16_d16_hi v128, v128
  ds_read_u16_d16_hi v129, v129
  v_mfma_f32_4x4x4_16b_bf16 v[88:91], v[216:217], v[208:209], v[88:91]
  v_add_u32_sdwa v130, v97, v97 dst_sel:DWORD dst_unused:UNUSED_PAD src0_sel:WORD_0 src1_sel:WORD_0
  v_add_u32_sdwa v131, v97, v97 dst_sel:DWORD dst_unused:UNUSED_PAD src0_sel:WORD_1 src1_sel:WORD_1
  ds_read_u16_d16_hi v130, v130
  ds_read_u16_d16_hi v131, v131
  v_mfma_f32_32x32x16_bf16 v[144:159], v[52:55], v[160:163], v[144:159]
  v_add_u32_sdwa v132, v98, v98 dst_sel:DWORD dst_unused:UNUSED_PAD src0_sel:WORD_0 src1_sel:WORD_0
  v_add_u32_sdwa v133, v98, v98 dst_sel:DWORD dst_unused:UNUSED_PAD src0_sel:WORD_1 src1_sel:WORD_1
  ds_read_u16_d16_hi v132, v132
  ds_read_u16_d16_hi v133, v133
  v_mfma_f32_4x4x4_16b_bf16 v[88:91], v[218:219], v[210:211], v[88:91]
  v_add_u32_sdwa v134, v99, v99 dst_sel:DWORD dst_unused:UNUSED_PAD src0_sel:WORD_0 src1_sel:WORD_0
  v_add_u32_sdwa v135, v99, v99 dst_sel:DWORD dst_unused:UNUSED_PAD src0_sel:WORD_1 src1_sel:WORD_1
  ds_read_u16_d16_hi v134, v134
  ds_read_u16_d16_hi v135, v135
  v_mfma_f32_32x32x16_bf16 v[144:159], v[60:63], v[164:167], v[144:159]
  v_add_u32_sdwa v136, v100, v100 dst_sel:DWORD dst_unused:UNUSED_PAD src0_sel:WORD_0 src1_sel:WORD_0
  v_add_u32_sdwa v137, v100, v100 dst_sel:DWORD dst_unused:UNUSED_PAD src0_sel:WORD_1 src1_sel:WORD_1
  ds_read_u16_d16_hi v136, v136
  ds_read_u16_d16_hi v137, v137
  v_mfma_f32_32x32x16_bf16 v[144:159], v[68:71], v[168:171], v[144:159]
  v_add_u32_sdwa v138, v101, v101 dst_sel:DWORD dst_unused:UNUSED_PAD src0_sel:WORD_0 src1_sel:WORD_0
  v_add_u32_sdwa v139, v101, v101 dst_sel:DWORD dst_unused:UNUSED_PAD src0_sel:WORD_1 src1_sel:WORD_1
  ds_read_u16_d16_hi v138, v138
  ds_read_u16_d16_hi v139, v139
  v_mfma_f32_4x4x4_16b_bf16 v[88:91], v[220:221], v[212:213], v[88:91]
  v_add_u32_sdwa v140, v102, v102 dst_sel:DWORD dst_unused:UNUSED_PAD src0_sel:WORD_0 src1_sel:WORD_0
  v_add_u32_sdwa v141, v102, v102 dst_sel:DWORD dst_unused:UNUSED_PAD src0_sel:WORD_1 src1_sel:WORD_1
  ds_read_u16_d16_hi v140, v140
  ds_read_u16_d16_hi v141, v141
  v_mfma_f32_32x32x16_bf16 v[144:159], v[76:79], v[172:175], v[144:159]
  v_add_u32_sdwa v142, v103, v103 dst_sel:DWORD dst_unused:UNUSED_PAD src0_sel:WORD_0 src1_sel:WORD_0
  v_add_u32_sdwa v143, v103, v103 dst_sel:DWORD dst_unused:UNUSED_PAD src0_sel:WORD_1 src1_sel:WORD_1
  ds_read_u16_d16_hi v142, v142
  ds_read_u16_d16_hi v143, v143
  v_mfma_f32_4x4x4_16b_bf16 v[88:91], v[222:223], v[214:215], v[88:91]
  s_cbranch_vccnz K2_SLOW1ce0
K2_BACK1ce0:
  v_lshlrev_b32 v180, 16, v250
  v_and_b32 v181, s60, v250
  v_lshlrev_b32 v182, 16, v251
  s_waitcnt lgkmcnt(8)
  v_lshlrev_b32 v244, 16, v228
  v_and_b32 v245, s60, v228
  v_add_f32 v128, v128, v244
  v_add_f32 v129, v129, v245
  v_cvt_pk_bf16_f32 v96, v128, v129
  v_lshlrev_b32 v246, 16, v229
  v_and_b32 v247, s60, v229
  v_add_f32 v130, v130, v246
  v_add_f32 v131, v131, v247
  v_cvt_pk_bf16_f32 v97, v130, v131
  v_cvt_pk_bf16_f32 v104, v144, v145
  v_cvt_pk_bf16_f32 v105, v146, v147
  v_cvt_pk_bf16_f32 v106, v148, v149
  v_cvt_pk_bf16_f32 v107, v150, v151
  v_cvt_pk_bf16_f32 v108, v152, v153
  v_cvt_pk_bf16_f32 v109, v154, v155
  v_cvt_pk_bf16_f32 v110, v156, v157
  v_cvt_pk_bf16_f32 v111, v158, v159
  v_or3_b32 v8, v104, v105, v106
  v_or3_b32 v8, v8, v107, v108
  v_or3_b32 v8, v8, v109, v110
  v_or3_b32 v8, v8, v111, s54
  v_cmp_ne_u32 vcc, s54, v8
  v_add_u32_sdwa v144, v104, v104 dst_sel:DWORD dst_unused:UNUSED_PAD src0_sel:WORD_0 src1_sel:WORD_0
  v_add_u32_sdwa v145, v104, v104 dst_sel:DWORD dst_unused:UNUSED_PAD src0_sel:WORD_1 src1_sel:WORD_1
  ds_read_u16_d16_hi v144, v144
  ds_read_u16_d16_hi v145, v145
  v_add_u32_sdwa v146, v105, v105 dst_sel:DWORD dst_unused:UNUSED_PAD src0_sel:WORD_0 src1_sel:WORD_0
  v_add_u32_sdwa v147, v105, v105 dst_sel:DWORD dst_unused:UNUSED_PAD src0_sel:WORD_1 src1_sel:WORD_1
  ds_read_u16_d16_hi v146, v146
  ds_read_u16_d16_hi v147, v147
  v_add_u32_sdwa v148, v106, v106 dst_sel:DWORD dst_unused:UNUSED_PAD src0_sel:WORD_0 src1_sel:WORD_0
  v_add_u32_sdwa v149, v106, v106 dst_sel:DWORD dst_unused:UNUSED_PAD src0_sel:WORD_1 src1_sel:WORD_1
  ds_read_u16_d16_hi v148, v148
  ds_read_u16_d16_hi v149, v149
  v_add_u32_sdwa v150, v107, v107 dst_sel:DWORD dst_unused:UNUSED_PAD src0_sel:WORD_0 src1_sel:WORD_0
  v_add_u32_sdwa v151, v107, v107 dst_sel:DWORD dst_unused:UNUSED_PAD src0_sel:WORD_1 src1_sel:WORD_1
  ds_read_u16_d16_hi v150, v150
  ds_read_u16_d16_hi v151, v151
  s_waitcnt lgkmcnt(8)
  v_add_u32_sdwa v152, v108, v108 dst_sel:DWORD dst_unused:UNUSED_PAD src0_sel:WORD_0 src1_sel:WORD_0
  v_add_u32_sdwa v153, v108, v108 dst_sel:DWORD dst_unused:UNUSED_PAD src0_sel:WORD_1 src1_sel:WORD_1
  ds_read_u16_d16_hi v152, v152
  ds_read_u16_d16_hi v153, v153
  v_add_u32_sdwa v154, v109, v109 dst_sel:DWORD dst_unused:UNUSED_PAD src0_sel:WORD_0 src1_sel:WORD_0
  v_add_u32_sdwa v155, v109, v109 dst_sel:DWORD dst_unused:UNUSED_PAD src0_sel:WORD_1 src1_sel:WORD_1
  ds_read_u16_d16_hi v154, v154
  ds_read_u16_d16_hi v155, v155
  v_add_u32_sdwa v156, v110, v110 dst_sel:DWORD dst_unused:UNUSED_PAD src0_sel:WORD_0 src1_sel:WORD_0
  v_add_u32_sdwa v157, v110, v110 dst_sel:DWORD dst_unused:UNUSED_PAD src0_sel:WORD_1 src1_sel:WORD_1
  ds_read_u16_d16_hi v156, v156
  ds_read_u16_d16_hi v157, v157
  v_add_u32_sdwa v158, v111, v111 dst_sel:DWORD dst_unused:UNUSED_PAD src0_sel:WORD_0 src1_sel:WORD_0
  v_add_u32_sdwa v159, v111, v111 dst_sel:DWORD dst_unused:UNUSED_PAD src0_sel:WORD_1 src1_sel:WORD_1
  ds_read_u16_d16_hi v158, v158
  ds_read_u16_d16_hi v159, v159
  v_lshlrev_b32 v244, 16, v230
  v_and_b32 v245, s60, v230
  v_add_f32 v132, v132, v244
  v_add_f32 v133, v133, v245
  v_cvt_pk_bf16_f32 v98, v132, v133
  v_lshlrev_b32 v246, 16, v231
  v_and_b32 v247, s60, v231
  v_add_f32 v134, v134, v246
  v_add_f32 v135, v135, v247
  v_cvt_pk_bf16_f32 v99, v134, v135
  s_mov_b64 exec, s[66:67]
  buffer_store_dwordx2 v[96:97], v4, s[32:35], 0 offen offset:0
  buffer_store_dwordx2 v[98:99], v4, s[32:35], 0 offen offset:16
  s_mov_b64 exec, -1
  v_lshlrev_b32 v244, 16, v232
  v_and_b32 v245, s60, v232
  v_add_f32 v136, v136, v244
  v_add_f32 v137, v137, v245
  v_cvt_pk_bf16_f32 v100, v136, v137
  v_lshlrev_b32 v246, 16, v233
  v_and_b32 v247, s60, v233
  v_add_f32 v138, v138, v246
  v_add_f32 v139, v139, v247
  v_cvt_pk_bf16_f32 v101, v138, v139
  v_lshlrev_b32 v244, 16, v234
  v_and_b32 v245, s60, v234
  v_add_f32 v140, v140, v244
  v_add_f32 v141, v141, v245
  v_cvt_pk_bf16_f32 v102, v140, v141
  v_lshlrev_b32 v246, 16, v235
  v_and_b32 v247, s60, v235
  v_add_f32 v142, v142, v246
  v_add_f32 v143, v143, v247
  v_cvt_pk_bf16_f32 v103, v142, v143
  s_mov_b64 exec, s[66:67]
  buffer_store_dwordx2 v[100:101], v4, s[32:35], 0 offen offset:32
  buffer_store_dwordx2 v[102:103], v4, s[32:35], 0 offen offset:48
  s_mov_b64 exec, -1
  s_cbranch_vccnz K2_SLOW1ce1
K2_BACK1ce1:
  s_waitcnt lgkmcnt(0)
  v_lshlrev_b32 v244, 16, v236
  v_and_b32 v245, s60, v236
  v_add_f32 v144, v144, v244
  v_add_f32 v145, v145, v245
  v_cvt_pk_bf16_f32 v104, v144, v145
  v_lshlrev_b32 v246, 16, v237
  v_and_b32 v247, s60, v237
  v_add_f32 v146, v146, v246
  v_add_f32 v147, v147, v247
  v_cvt_pk_bf16_f32 v105, v146, v147
  v_lshlrev_b32 v244, 16, v238
  v_and_b32 v245, s60, v238
  v_add_f32 v148, v148, v244
  v_add_f32 v149, v149, v245
  v_cvt_pk_bf16_f32 v106, v148, v149
  v_lshlrev_b32 v246, 16, v239
  v_and_b32 v247, s60, v239
  v_add_f32 v150, v150, v246
  v_add_f32 v151, v151, v247
  v_cvt_pk_bf16_f32 v107, v150, v151
  s_mov_b64 exec, s[66:67]
  buffer_store_dwordx2 v[104:105], v4, s[32:35], 0 offen offset:64
  buffer_store_dwordx2 v[106:107], v4, s[32:35], 0 offen offset:80
  s_mov_b64 exec, -1
  v_lshlrev_b32 v244, 16, v240
  v_and_b32 v245, s60, v240
  v_add_f32 v152, v152, v244
  v_add_f32 v153, v153, v245
  v_cvt_pk_bf16_f32 v108, v152, v153
  v_lshlrev_b32 v246, 16, v241
  v_and_b32 v247, s60, v241
  v_add_f32 v154, v154, v246
  v_add_f32 v155, v155, v247
  v_cvt_pk_bf16_f32 v109, v154, v155
  v_lshlrev_b32 v244, 16, v242
  v_and_b32 v245, s60, v242
  v_add_f32 v156, v156, v244
  v_add_f32 v157, v157, v245
  v_cvt_pk_bf16_f32 v110, v156, v157
  v_lshlrev_b32 v246, 16, v243
  v_and_b32 v247, s60, v243
  v_add_f32 v158, v158, v246
  v_add_f32 v159, v159, v247
  v_cvt_pk_bf16_f32 v111, v158, v159
  s_mov_b64 exec, s[66:67]
  buffer_store_dwordx2 v[108:109], v4, s[32:35], 0 offen offset:96
  buffer_store_dwordx2 v[110:111], v4, s[32:35], 0 offen offset:112
  s_mov_b64 exec, -1
  v_mov_b32 v176, v88
  v_mov_b32 v177, v89
  v_mov_b32 v178, v90
  v_permlane32_swap_b32 v176, v88
  v_permlane32_swap_b32 v177, v89
  v_permlane32_swap_b32 v178, v90
  v_add_f32 v176, v176, v88
  v_add_f32 v177, v177, v89
  v_add_f32 v178, v178, v90
  v_cvt_pk_bf16_f32 v176, 0, v176
  v_cvt_pk_bf16_f32 v177, 0, v177
  v_cvt_pk_bf16_f32 v178, 0, v178
  v_add_f32 v176, v176, v180
  v_add_f32 v177, v177, v181
  v_add_f32 v178, v178, v182
  v_cvt_pk_bf16_f32 v176, v176, v176
  v_cvt_pk_bf16_f32 v177, v177, v177
  v_cvt_pk_bf16_f32 v178, v178, v178
  s_mov_b32 exec_lo, s66
  s_mov_b32 exec_hi, 0
  s_mov_b32 s61, 6400000
  buffer_store_short v176, v5, s[32:35], s61 offen offset:0
  buffer_store_short v177, v5, s[32:35], s61 offen offset:2
  buffer_store_short v178, v5, s[32:35], s61 offen offset:4
  s_endpgm
K2_EPI:
  s_waitcnt vmcnt(0)
  v_lshlrev_b32 v250, 4, v0
  s_mov_b32 s61, 12611584
  buffer_load_dwordx4 v[48:51], v250, s[28:31], s61 offen offset:0
  buffer_load_dwordx4 v[52:55], v250, s[28:31], s61 offen offset:1024
  buffer_load_dwordx4 v[56:59], v250, s[28:31], s61 offen offset:2048
  buffer_load_dwordx4 v[60:63], v250, s[28:31], s61 offen offset:3072
  s_add_u32 s61, s61, 4096
  buffer_load_dwordx4 v[64:67], v250, s[28:31], s61 offen offset:0
  buffer_load_dwordx4 v[68:71], v250, s[28:31], s61 offen offset:1024
  buffer_load_dwordx4 v[72:75], v250, s[28:31], s61 offen offset:2048
  buffer_load_dwordx4 v[76:79], v250, s[28:31], s61 offen offset:3072
  v_add_u32 v192, 16384, v250
  v_add_u32 v193, 81920, v250
  v_add_u32 v194, 147456, v250
  ds_read_b128 v[16:19], v192 offset:15136
  ds_read_b128 v[20:23], v192 offset:31520
  ds_read_b128 v[24:27], v192 offset:47904
  ds_read_b128 v[28:31], v193 offset:15136
  ds_read_b128 v[32:35], v193 offset:31520
  ds_read_b128 v[36:39], v193 offset:47904
  ds_read_b128 v[40:43], v193 offset:64288
  ds_read_b128 v[44:47], v194 offset:15136
K2_EPI2:
  v_and_b32 v246, 31, v0
  v_min_u32 v249, 25, v246
  v_mul_u32_u24 v249, 144, v249
  v_add_u32 v251, v249, v2
  ds_read_b128 v[176:179], v251 offset:9088
  ds_read_b128 v[180:183], v251 offset:9120
  ds_read_b128 v[184:187], v251 offset:9152
  ds_read_b128 v[188:191], v251 offset:9184
  v_lshrrev_b32 v252, 1, v1
  v_add_u32 v252, v249, v252
  v_add_u32 v252, s50, v252
  ds_read_b64 v[192:193], v252 offset:9088
  ds_read_b64 v[194:195], v252 offset:9104
  ds_read_b64 v[196:197], v252 offset:9120
  ds_read_b64 v[198:199], v252 offset:9136
  ds_read_b64 v[200:201], v252 offset:9152
  ds_read_b64 v[202:203], v252 offset:9168
  ds_read_b64 v[204:205], v252 offset:9184
  ds_read_b64 v[206:207], v252 offset:9200
  v_mov_b32 v218, v88
  v_mov_b32 v219, v89
  v_mov_b32 v220, v90
  v_permlane32_swap_b32 v218, v88
  v_permlane32_swap_b32 v219, v89
  v_permlane32_swap_b32 v220, v90
  v_add_f32 v218, v218, v88
  v_add_f32 v219, v219, v89
  v_add_f32 v220, v220, v90
  v_add_u32 v230, s40, v246
  v_mul_u32_u24 v231, 6, v230
  buffer_load_ushort v222, v231, s[20:23], 0 offen offset:0
  buffer_load_ushort v223, v231, s[20:23], 0 offen offset:2
  buffer_load_ushort v224, v231, s[20:23], 0 offen offset:4
  v_cvt_pk_bf16_f32 v160, v96, v97
  v_cvt_pk_bf16_f32 v161, v98, v99
  v_cvt_pk_bf16_f32 v162, v100, v101
  v_cvt_pk_bf16_f32 v163, v102, v103
  v_cvt_pk_bf16_f32 v164, v104, v105
  v_cvt_pk_bf16_f32 v165, v106, v107
  v_cvt_pk_bf16_f32 v166, v108, v109
  v_cvt_pk_bf16_f32 v167, v110, v111
  v_cvt_pk_bf16_f32 v168, v112, v113
  v_cvt_pk_bf16_f32 v169, v114, v115
  v_cvt_pk_bf16_f32 v170, v116, v117
  v_cvt_pk_bf16_f32 v171, v118, v119
  v_cvt_pk_bf16_f32 v172, v120, v121
  v_cvt_pk_bf16_f32 v173, v122, v123
  v_cvt_pk_bf16_f32 v174, v124, v125
  v_cvt_pk_bf16_f32 v175, v126, v127
  s_waitcnt vmcnt(3) lgkmcnt(0)
  v_mfma_f32_32x32x16_bf16 v[128:143], v[16:19], v[176:179], 0
  v_mfma_f32_32x32x16_bf16 v[128:143], v[24:27], v[180:183], v[128:143]
  v_mfma_f32_32x32x16_bf16 v[128:143], v[32:35], v[184:187], v[128:143]
  v_mfma_f32_32x32x16_bf16 v[128:143], v[40:43], v[188:191], v[128:143]
  v_cmp_gt_u32 s[66:67], s42, v246
  v_lshrrev_b32 v252, 1, v1
  v_lshl_add_u32 v252, v230, 7, v252
  v_mfma_f32_32x32x16_bf16 v[128:143], v[48:51], v[160:163], v[128:143]
  v_mfma_f32_32x32x16_bf16 v[128:143], v[56:59], v[164:167], v[128:143]
  v_mfma_f32_32x32x16_bf16 v[128:143], v[64:67], v[168:171], v[128:143]
  v_mfma_f32_32x32x16_bf16 v[128:143], v[72:75], v[172:175], v[128:143]
  v_mfma_f32_32x32x16_bf16 v[144:159], v[20:23], v[176:179], 0
  v_mfma_f32_32x32x16_bf16 v[144:159], v[28:31], v[180:183], v[144:159]
  s_nop 7
  s_nop 1
  v_cvt_pk_bf16_f32 v96, v128, v129
  v_cvt_pk_bf16_f32 v97, v130, v131
  v_cvt_pk_bf16_f32 v98, v132, v133
  v_cvt_pk_bf16_f32 v99, v134, v135
  v_cvt_pk_bf16_f32 v100, v136, v137
  v_mfma_f32_32x32x16_bf16 v[144:159], v[36:39], v[184:187], v[144:159]
  v_cvt_pk_bf16_f32 v101, v138, v139
  v_cvt_pk_bf16_f32 v102, v140, v141
  v_cvt_pk_bf16_f32 v103, v142, v143
  v_or3_b32 v8, v96, v97, v98
  v_or3_b32 v8, v8, v99, v100
  v_or3_b32 v8, v8, v101, v102
  v_mfma_f32_32x32x16_bf16 v[144:159], v[44:47], v[188:191], v[144:159]
  v_or3_b32 v8, v8, v103, s54
  v_cmp_ne_u32 vcc, s54, v8
  v_add_u32_sdwa v128, v96, v96 dst_sel:DWORD dst_unused:UNUSED_PAD src0_sel:WORD_0 src1_sel:WORD_0
  v_add_u32_sdwa v129, v96, v96 dst_sel:DWORD dst_unused:UNUSED_PAD src0_sel:WORD_1 src1_sel:WORD_1
  ds_read_u16_d16_hi v128, v128
  ds_read_u16_d16_hi v129, v129
  v_mfma_f32_32x32x16_bf16 v[144:159], v[52:55], v[160:163], v[144:159]
  v_add_u32_sdwa v130, v97, v97 dst_sel:DWORD dst_unused:UNUSED_PAD src0_sel:WORD_0 src1_sel:WORD_0
  v_add_u32_sdwa v131, v97, v97 dst_sel:DWORD dst_unused:UNUSED_PAD src0_sel:WORD_1 src1_sel:WORD_1
  ds_read_u16_d16_hi v130, v130
  ds_read_u16_d16_hi v131, v131
  v_add_u32_sdwa v132, v98, v98 dst_sel:DWORD dst_unused:UNUSED_PAD src0_sel:WORD_0 src1_sel:WORD_0
  v_add_u32_sdwa v133, v98, v98 dst_sel:DWORD dst_unused:UNUSED_PAD src0_sel:WORD_1 src1_sel:WORD_1
  ds_read_u16_d16_hi v132, v132
  ds_read_u16_d16_hi v133, v133
  v_mfma_f32_32x32x16_bf16 v[144:159], v[60:63], v[164:167], v[144:159]
  v_add_u32_sdwa v134, v99, v99 dst_sel:DWORD dst_unused:UNUSED_PAD src0_sel:WORD_0 src1_sel:WORD_0
  v_add_u32_sdwa v135, v99, v99 dst_sel:DWORD dst_unused:UNUSED_PAD src0_sel:WORD_1 src1_sel:WORD_1
  ds_read_u16_d16_hi v134, v134
  ds_read_u16_d16_hi v135, v135
  v_add_u32_sdwa v136, v100, v100 dst_sel:DWORD dst_unused:UNUSED_PAD src0_sel:WORD_0 src1_sel:WORD_0
  v_add_u32_sdwa v137, v100, v100 dst_sel:DWORD dst_unused:UNUSED_PAD src0_sel:WORD_1 src1_sel:WORD_1
  ds_read_u16_d16_hi v136, v136
  ds_read_u16_d16_hi v137, v137
  v_mfma_f32_32x32x16_bf16 v[144:159], v[68:71], v[168:171], v[144:159]
  v_add_u32_sdwa v138, v101, v101 dst_sel:DWORD dst_unused:UNUSED_PAD src0_sel:WORD_0 src1_sel:WORD_0
  v_add_u32_sdwa v139, v101, v101 dst_sel:DWORD dst_unused:UNUSED_PAD src0_sel:WORD_1 src1_sel:WORD_1
  ds_read_u16_d16_hi v138, v138
  ds_read_u16_d16_hi v139, v139
  v_mfma_f32_32x32x16_bf16 v[144:159], v[76:79], v[172:175], v[144:159]
  v_add_u32_sdwa v140, v102, v102 dst_sel:DWORD dst_unused:UNUSED_PAD src0_sel:WORD_0 src1_sel:WORD_0
  v_add_u32_sdwa v141, v102, v102 dst_sel:DWORD dst_unused:UNUSED_PAD src0_sel:WORD_1 src1_sel:WORD_1
  ds_read_u16_d16_hi v140, v140
  ds_read_u16_d16_hi v141, v141
  v_add_u32_sdwa v142, v103, v103 dst_sel:DWORD dst_unused:UNUSED_PAD src0_sel:WORD_0 src1_sel:WORD_0
  v_add_u32_sdwa v143, v103, v103 dst_sel:DWORD dst_unused:UNUSED_PAD src0_sel:WORD_1 src1_sel:WORD_1
  ds_read_u16_d16_hi v142, v142
  ds_read_u16_d16_hi v143, v143
  s_cbranch_vccnz K2_SLOWe0
K2_BACKe0:
  s_waitcnt lgkmcnt(8)
  v_lshlrev_b32 v248, 16, v192
  v_and_b32 v249, s60, v192
  v_add_f32 v128, v128, v248
  v_add_f32 v129, v129, v249
  v_cvt_pk_bf16_f32 v96, v128, v129
  v_lshlrev_b32 v250, 16, v193
  v_and_b32 v251, s60, v193
  v_add_f32 v130, v130, v250
  v_add_f32 v131, v131, v251
  v_cvt_pk_bf16_f32 v97, v130, v131
  v_cvt_pk_bf16_f32 v104, v144, v145
  v_cvt_pk_bf16_f32 v105, v146, v147
  v_cvt_pk_bf16_f32 v106, v148, v149
  v_cvt_pk_bf16_f32 v107, v150, v151
  v_cvt_pk_bf16_f32 v108, v152, v153
  v_cvt_pk_bf16_f32 v109, v154, v155
  v_cvt_pk_bf16_f32 v110, v156, v157
  v_cvt_pk_bf16_f32 v111, v158, v159
  v_or3_b32 v8, v104, v105, v106
  v_or3_b32 v8, v8, v107, v108
  v_or3_b32 v8, v8, v109, v110
  v_or3_b32 v8, v8, v111, s54
  v_cmp_ne_u32 vcc, s54, v8
  v_add_u32_sdwa v144, v104, v104 dst_sel:DWORD dst_unused:UNUSED_PAD src0_sel:WORD_0 src1_sel:WORD_0
  v_add_u32_sdwa v145, v104, v104 dst_sel:DWORD dst_unused:UNUSED_PAD src0_sel:WORD_1 src1_sel:WORD_1
  ds_read_u16_d16_hi v144, v144
  ds_read_u16_d16_hi v145, v145
  v_add_u32_sdwa v146, v105, v105 dst_sel:DWORD dst_unused:UNUSED_PAD src0_sel:WORD_0 src1_sel:WORD_0
  v_add_u32_sdwa v147, v105, v105 dst_sel:DWORD dst_unused:UNUSED_PAD src0_sel:WORD_1 src1_sel:WORD_1
  ds_read_u16_d16_hi v146, v146
  ds_read_u16_d16_hi v147, v147
  v_add_u32_sdwa v148, v106, v106 dst_sel:DWORD dst_unused:UNUSED_PAD src0_sel:WORD_0 src1_sel:WORD_0
  v_add_u32_sdwa v149, v106, v106 dst_sel:DWORD dst_unused:UNUSED_PAD src0_sel:WORD_1 src1_sel:WORD_1
  ds_read_u16_d16_hi v148, v148
  ds_read_u16_d16_hi v149, v149
  v_add_u32_sdwa v150, v107, v107 dst_sel:DWORD dst_unused:UNUSED_PAD src0_sel:WORD_0 src1_sel:WORD_0
  v_add_u32_sdwa v151, v107, v107 dst_sel:DWORD dst_unused:UNUSED_PAD src0_sel:WORD_1 src1_sel:WORD_1
  ds_read_u16_d16_hi v150, v150
  ds_read_u16_d16_hi v151, v151
  s_waitcnt lgkmcnt(8)
  v_add_u32_sdwa v152, v108, v108 dst_sel:DWORD dst_unused:UNUSED_PAD src0_sel:WORD_0 src1_sel:WORD_0
  v_add_u32_sdwa v153, v108, v108 dst_sel:DWORD dst_unused:UNUSED_PAD src0_sel:WORD_1 src1_sel:WORD_1
  ds_read_u16_d16_hi v152, v152
  ds_read_u16_d16_hi v153, v153
  v_add_u32_sdwa v154, v109, v109 dst_sel:DWORD dst_unused:UNUSED_PAD src0_sel:WORD_0 src1_sel:WORD_0
  v_add_u32_sdwa v155, v109, v109 dst_sel:DWORD dst_unused:UNUSED_PAD src0_sel:WORD_1 src1_sel:WORD_1
  ds_read_u16_d16_hi v154, v154
  ds_read_u16_d16_hi v155, v155
  v_add_u32_sdwa v156, v110, v110 dst_sel:DWORD dst_unused:UNUSED_PAD src0_sel:WORD_0 src1_sel:WORD_0
  v_add_u32_sdwa v157, v110, v110 dst_sel:DWORD dst_unused:UNUSED_PAD src0_sel:WORD_1 src1_sel:WORD_1
  ds_read_u16_d16_hi v156, v156
  ds_read_u16_d16_hi v157, v157
  v_add_u32_sdwa v158, v111, v111 dst_sel:DWORD dst_unused:UNUSED_PAD src0_sel:WORD_0 src1_sel:WORD_0
  v_add_u32_sdwa v159, v111, v111 dst_sel:DWORD dst_unused:UNUSED_PAD src0_sel:WORD_1 src1_sel:WORD_1
  ds_read_u16_d16_hi v158, v158
  ds_read_u16_d16_hi v159, v159
  v_lshlrev_b32 v248, 16, v194
  v_and_b32 v249, s60, v194
  v_add_f32 v132, v132, v248
  v_add_f32 v133, v133, v249
  v_cvt_pk_bf16_f32 v98, v132, v133
  v_lshlrev_b32 v250, 16, v195
  v_and_b32 v251, s60, v195
  v_add_f32 v134, v134, v250
  v_add_f32 v135, v135, v251
  v_cvt_pk_bf16_f32 v99, v134, v135
  s_mov_b64 exec, s[66:67]
  buffer_store_dwordx2 v[96:97], v252, s[32:35], 0 offen offset:0
  buffer_store_dwordx2 v[98:99], v252, s[32:35], 0 offen offset:16
  s_mov_b64 exec, -1
  v_lshlrev_b32 v248, 16, v196
  v_and_b32 v249, s60, v196
  v_add_f32 v136, v136, v248
  v_add_f32 v137, v137, v249
  v_cvt_pk_bf16_f32 v100, v136, v137
  v_lshlrev_b32 v250, 16, v197
  v_and_b32 v251, s60, v197
  v_add_f32 v138, v138, v250
  v_add_f32 v139, v139, v251
  v_cvt_pk_bf16_f32 v101, v138, v139
  v_lshlrev_b32 v248, 16, v198
  v_and_b32 v249, s60, v198
  v_add_f32 v140, v140, v248
  v_add_f32 v141, v141, v249
  v_cvt_pk_bf16_f32 v102, v140, v141
  v_lshlrev_b32 v250, 16, v199
  v_and_b32 v251, s60, v199
  v_add_f32 v142, v142, v250
  v_add_f32 v143, v143, v251
  v_cvt_pk_bf16_f32 v103, v142, v143
  s_mov_b64 exec, s[66:67]
  buffer_store_dwordx2 v[100:101], v252, s[32:35], 0 offen offset:32
  buffer_store_dwordx2 v[102:103], v252, s[32:35], 0 offen offset:48
  s_mov_b64 exec, -1
  s_cbranch_vccnz K2_SLOWe1
K2_BACKe1:
  s_waitcnt lgkmcnt(8)
  v_lshlrev_b32 v248, 16, v200
  v_and_b32 v249, s60, v200
  v_add_f32 v144, v144, v248
  v_add_f32 v145, v145, v249
  v_cvt_pk_bf16_f32 v104, v144, v145
  v_lshlrev_b32 v250, 16, v201
  v_and_b32 v251, s60, v201
  v_add_f32 v146, v146, v250
  v_add_f32 v147, v147, v251
  v_cvt_pk_bf16_f32 v105, v146, v147
  v_lshlrev_b32 v248, 16, v202
  v_and_b32 v249, s60, v202
  v_add_f32 v148, v148, v248
  v_add_f32 v149, v149, v249
  v_cvt_pk_bf16_f32 v106, v148, v149
  v_lshlrev_b32 v250, 16, v203
  v_and_b32 v251, s60, v203
  v_add_f32 v150, v150, v250
  v_add_f32 v151, v151, v251
  v_cvt_pk_bf16_f32 v107, v150, v151
  s_mov_b64 exec, s[66:67]
  buffer_store_dwordx2 v[104:105], v252, s[32:35], 0 offen offset:64
  buffer_store_dwordx2 v[106:107], v252, s[32:35], 0 offen offset:80
  s_mov_b64 exec, -1
  s_waitcnt lgkmcnt(0)
  v_lshlrev_b32 v248, 16, v204
  v_and_b32 v249, s60, v204
  v_add_f32 v152, v152, v248
  v_add_f32 v153, v153, v249
  v_cvt_pk_bf16_f32 v108, v152, v153
  v_lshlrev_b32 v250, 16, v205
  v_and_b32 v251, s60, v205
  v_add_f32 v154, v154, v250
  v_add_f32 v155, v155, v251
  v_cvt_pk_bf16_f32 v109, v154, v155
  v_lshlrev_b32 v248, 16, v206
  v_and_b32 v249, s60, v206
  v_add_f32 v156, v156, v248
  v_add_f32 v157, v157, v249
  v_cvt_pk_bf16_f32 v110, v156, v157
  v_lshlrev_b32 v250, 16, v207
  v_and_b32 v251, s60, v207
  v_add_f32 v158, v158, v250
  v_add_f32 v159, v159, v251
  v_cvt_pk_bf16_f32 v111, v158, v159
  s_mov_b64 exec, s[66:67]
  buffer_store_dwordx2 v[108:109], v252, s[32:35], 0 offen offset:96
  buffer_store_dwordx2 v[110:111], v252, s[32:35], 0 offen offset:112
  s_mov_b64 exec, -1
  s_mov_b64 exec, s[66:67]
  s_waitcnt vmcnt(8)
  v_cvt_pk_bf16_f32 v226, v218, v219
  v_cvt_pk_bf16_f32 v227, v220, v220
  v_lshlrev_b32 v218, 16, v226
  v_and_b32 v219, s60, v226
  v_lshlrev_b32 v220, 16, v227
  v_lshlrev_b32 v222, 16, v222
  v_add_f32 v222, v222, v218
  v_cvt_pk_bf16_f32 v222, v222, v222
  v_lshlrev_b32 v223, 16, v223
  v_add_f32 v223, v223, v219
  v_cvt_pk_bf16_f32 v223, v223, v223
  v_lshlrev_b32 v224, 16, v224
  v_add_f32 v224, v224, v220
  v_cvt_pk_bf16_f32 v224, v224, v224
  v_cmp_gt_u32 vcc, 32, v0
  s_and_b64 exec, exec, vcc
  s_mov_b32 s61, 6400000
  buffer_store_short v222, v231, s[32:35], s61 offen offset:0
  buffer_store_short v223, v231, s[32:35], s61 offen offset:2
  buffer_store_short v224, v231, s[32:35], s61 offen offset:4
K2_FIN:
K2_END:
  s_endpgm
K2_SLOW0a:
  s_waitcnt lgkmcnt(0)
  v_lshlrev_b32 v128, 16, v160
  v_and_b32 v129, s60, v160
  v_mul_f32 v128, 0x62800000, v128
  v_mul_f32 v8, s46, v128
  v_exp_f32 v8, v8
  s_nop 0
  v_add_f32 v8, 1.0, v8
  v_rcp_f32 v8, v8
  s_nop 0
  v_mul_f32 v128, v128, v8
  v_mul_f32 v129, 0x62800000, v129
  v_mul_f32 v8, s46, v129
  v_exp_f32 v8, v8
  s_nop 0
  v_add_f32 v8, 1.0, v8
  v_rcp_f32 v8, v8
  s_nop 0
  v_mul_f32 v129, v129, v8
  v_cvt_pk_bf16_f32 v8, v128, v129
  v_lshlrev_b32 v128, 16, v8
  v_and_b32 v129, s60, v8
  v_lshlrev_b32 v130, 16, v161
  v_and_b32 v131, s60, v161
  v_mul_f32 v130, 0x62800000, v130
  v_mul_f32 v8, s46, v130
  v_exp_f32 v8, v8
  s_nop 0
  v_add_f32 v8, 1.0, v8
  v_rcp_f32 v8, v8
  s_nop 0
  v_mul_f32 v130, v130, v8
  v_mul_f32 v131, 0x62800000, v131
  v_mul_f32 v8, s46, v131
  v_exp_f32 v8, v8
  s_nop 0
  v_add_f32 v8, 1.0, v8
  v_rcp_f32 v8, v8
  s_nop 0
  v_mul_f32 v131, v131, v8
  v_cvt_pk_bf16_f32 v8, v130, v131
  v_lshlrev_b32 v130, 16, v8
  v_and_b32 v131, s60, v8
  v_lshlrev_b32 v132, 16, v162
  v_and_b32 v133, s60, v162
  v_mul_f32 v132, 0x62800000, v132
  v_mul_f32 v8, s46, v132
  v_exp_f32 v8, v8
  s_nop 0
  v_add_f32 v8, 1.0, v8
  v_rcp_f32 v8, v8
  s_nop 0
  v_mul_f32 v132, v132, v8
  v_mul_f32 v133, 0x62800000, v133
  v_mul_f32 v8, s46, v133
  v_exp_f32 v8, v8
  s_nop 0
  v_add_f32 v8, 1.0, v8
  v_rcp_f32 v8, v8
  s_nop 0
  v_mul_f32 v133, v133, v8
  v_cvt_pk_bf16_f32 v8, v132, v133
  v_lshlrev_b32 v132, 16, v8
  v_and_b32 v133, s60, v8
  v_lshlrev_b32 v134, 16, v163
  v_and_b32 v135, s60, v163
  v_mul_f32 v134, 0x62800000, v134
  v_mul_f32 v8, s46, v134
  v_exp_f32 v8, v8
  s_nop 0
  v_add_f32 v8, 1.0, v8
  v_rcp_f32 v8, v8
  s_nop 0
  v_mul_f32 v134, v134, v8
  v_mul_f32 v135, 0x62800000, v135
  v_mul_f32 v8, s46, v135
  v_exp_f32 v8, v8
  s_nop 0
  v_add_f32 v8, 1.0, v8
  v_rcp_f32 v8, v8
  s_nop 0
  v_mul_f32 v135, v135, v8
  v_cvt_pk_bf16_f32 v8, v134, v135
  v_lshlrev_b32 v134, 16, v8
  v_and_b32 v135, s60, v8
  v_lshlrev_b32 v136, 16, v164
  v_and_b32 v137, s60, v164
  v_mul_f32 v136, 0x62800000, v136
  v_mul_f32 v8, s46, v136
  v_exp_f32 v8, v8
  s_nop 0
  v_add_f32 v8, 1.0, v8
  v_rcp_f32 v8, v8
  s_nop 0
  v_mul_f32 v136, v136, v8
  v_mul_f32 v137, 0x62800000, v137
  v_mul_f32 v8, s46, v137
  v_exp_f32 v8, v8
  s_nop 0
  v_add_f32 v8, 1.0, v8
  v_rcp_f32 v8, v8
  s_nop 0
  v_mul_f32 v137, v137, v8
  v_cvt_pk_bf16_f32 v8, v136, v137
  v_lshlrev_b32 v136, 16, v8
  v_and_b32 v137, s60, v8
  v_lshlrev_b32 v138, 16, v165
  v_and_b32 v139, s60, v165
  v_mul_f32 v138, 0x62800000, v138
  v_mul_f32 v8, s46, v138
  v_exp_f32 v8, v8
  s_nop 0
  v_add_f32 v8, 1.0, v8
  v_rcp_f32 v8, v8
  s_nop 0
  v_mul_f32 v138, v138, v8
  v_mul_f32 v139, 0x62800000, v139
  v_mul_f32 v8, s46, v139
  v_exp_f32 v8, v8
  s_nop 0
  v_add_f32 v8, 1.0, v8
  v_rcp_f32 v8, v8
  s_nop 0
  v_mul_f32 v139, v139, v8
  v_cvt_pk_bf16_f32 v8, v138, v139
  v_lshlrev_b32 v138, 16, v8
  v_and_b32 v139, s60, v8
  v_lshlrev_b32 v140, 16, v166
  v_and_b32 v141, s60, v166
  v_mul_f32 v140, 0x62800000, v140
  v_mul_f32 v8, s46, v140
  v_exp_f32 v8, v8
  s_nop 0
  v_add_f32 v8, 1.0, v8
  v_rcp_f32 v8, v8
  s_nop 0
  v_mul_f32 v140, v140, v8
  v_mul_f32 v141, 0x62800000, v141
  v_mul_f32 v8, s46, v141
  v_exp_f32 v8, v8
  s_nop 0
  v_add_f32 v8, 1.0, v8
  v_rcp_f32 v8, v8
  s_nop 0
  v_mul_f32 v141, v141, v8
  v_cvt_pk_bf16_f32 v8, v140, v141
  v_lshlrev_b32 v140, 16, v8
  v_and_b32 v141, s60, v8
  v_lshlrev_b32 v142, 16, v167
  v_and_b32 v143, s60, v167
  v_mul_f32 v142, 0x62800000, v142
  v_mul_f32 v8, s46, v142
  v_exp_f32 v8, v8
  s_nop 0
  v_add_f32 v8, 1.0, v8
  v_rcp_f32 v8, v8
  s_nop 0
  v_mul_f32 v142, v142, v8
  v_mul_f32 v143, 0x62800000, v143
  v_mul_f32 v8, s46, v143
  v_exp_f32 v8, v8
  s_nop 0
  v_add_f32 v8, 1.0, v8
  v_rcp_f32 v8, v8
  s_nop 0
  v_mul_f32 v143, v143, v8
  v_cvt_pk_bf16_f32 v8, v142, v143
  v_lshlrev_b32 v142, 16, v8
  v_and_b32 v143, s60, v8
  s_nop 1
  s_branch K2_BACK0a
K2_SLOW0b:
  s_waitcnt lgkmcnt(0)
  v_lshlrev_b32 v144, 16, v168
  v_and_b32 v145, s60, v168
  v_mul_f32 v144, 0x62800000, v144
  v_mul_f32 v8, s46, v144
  v_exp_f32 v8, v8
  s_nop 0
  v_add_f32 v8, 1.0, v8
  v_rcp_f32 v8, v8
  s_nop 0
  v_mul_f32 v144, v144, v8
  v_mul_f32 v145, 0x62800000, v145
  v_mul_f32 v8, s46, v145
  v_exp_f32 v8, v8
  s_nop 0
  v_add_f32 v8, 1.0, v8
  v_rcp_f32 v8, v8
  s_nop 0
  v_mul_f32 v145, v145, v8
  v_cvt_pk_bf16_f32 v8, v144, v145
  v_lshlrev_b32 v144, 16, v8
  v_and_b32 v145, s60, v8
  v_lshlrev_b32 v146, 16, v169
  v_and_b32 v147, s60, v169
  v_mul_f32 v146, 0x62800000, v146
  v_mul_f32 v8, s46, v146
  v_exp_f32 v8, v8
  s_nop 0
  v_add_f32 v8, 1.0, v8
  v_rcp_f32 v8, v8
  s_nop 0
  v_mul_f32 v146, v146, v8
  v_mul_f32 v147, 0x62800000, v147
  v_mul_f32 v8, s46, v147
  v_exp_f32 v8, v8
  s_nop 0
  v_add_f32 v8, 1.0, v8
  v_rcp_f32 v8, v8
  s_nop 0
  v_mul_f32 v147, v147, v8
  v_cvt_pk_bf16_f32 v8, v146, v147
  v_lshlrev_b32 v146, 16, v8
  v_and_b32 v147, s60, v8
  v_lshlrev_b32 v148, 16, v170
  v_and_b32 v149, s60, v170
  v_mul_f32 v148, 0x62800000, v148
  v_mul_f32 v8, s46, v148
  v_exp_f32 v8, v8
  s_nop 0
  v_add_f32 v8, 1.0, v8
  v_rcp_f32 v8, v8
  s_nop 0
  v_mul_f32 v148, v148, v8
  v_mul_f32 v149, 0x62800000, v149
  v_mul_f32 v8, s46, v149
  v_exp_f32 v8, v8
  s_nop 0
  v_add_f32 v8, 1.0, v8
  v_rcp_f32 v8, v8
  s_nop 0
  v_mul_f32 v149, v149, v8
  v_cvt_pk_bf16_f32 v8, v148, v149
  v_lshlrev_b32 v148, 16, v8
  v_and_b32 v149, s60, v8
  v_lshlrev_b32 v150, 16, v171
  v_and_b32 v151, s60, v171
  v_mul_f32 v150, 0x62800000, v150
  v_mul_f32 v8, s46, v150
  v_exp_f32 v8, v8
  s_nop 0
  v_add_f32 v8, 1.0, v8
  v_rcp_f32 v8, v8
  s_nop 0
  v_mul_f32 v150, v150, v8
  v_mul_f32 v151, 0x62800000, v151
  v_mul_f32 v8, s46, v151
  v_exp_f32 v8, v8
  s_nop 0
  v_add_f32 v8, 1.0, v8
  v_rcp_f32 v8, v8
  s_nop 0
  v_mul_f32 v151, v151, v8
  v_cvt_pk_bf16_f32 v8, v150, v151
  v_lshlrev_b32 v150, 16, v8
  v_and_b32 v151, s60, v8
  v_lshlrev_b32 v152, 16, v172
  v_and_b32 v153, s60, v172
  v_mul_f32 v152, 0x62800000, v152
  v_mul_f32 v8, s46, v152
  v_exp_f32 v8, v8
  s_nop 0
  v_add_f32 v8, 1.0, v8
  v_rcp_f32 v8, v8
  s_nop 0
  v_mul_f32 v152, v152, v8
  v_mul_f32 v153, 0x62800000, v153
  v_mul_f32 v8, s46, v153
  v_exp_f32 v8, v8
  s_nop 0
  v_add_f32 v8, 1.0, v8
  v_rcp_f32 v8, v8
  s_nop 0
  v_mul_f32 v153, v153, v8
  v_cvt_pk_bf16_f32 v8, v152, v153
  v_lshlrev_b32 v152, 16, v8
  v_and_b32 v153, s60, v8
  v_lshlrev_b32 v154, 16, v173
  v_and_b32 v155, s60, v173
  v_mul_f32 v154, 0x62800000, v154
  v_mul_f32 v8, s46, v154
  v_exp_f32 v8, v8
  s_nop 0
  v_add_f32 v8, 1.0, v8
  v_rcp_f32 v8, v8
  s_nop 0
  v_mul_f32 v154, v154, v8
  v_mul_f32 v155, 0x62800000, v155
  v_mul_f32 v8, s46, v155
  v_exp_f32 v8, v8
  s_nop 0
  v_add_f32 v8, 1.0, v8
  v_rcp_f32 v8, v8
  s_nop 0
  v_mul_f32 v155, v155, v8
  v_cvt_pk_bf16_f32 v8, v154, v155
  v_lshlrev_b32 v154, 16, v8
  v_and_b32 v155, s60, v8
  v_lshlrev_b32 v156, 16, v174
  v_and_b32 v157, s60, v174
  v_mul_f32 v156, 0x62800000, v156
  v_mul_f32 v8, s46, v156
  v_exp_f32 v8, v8
  s_nop 0
  v_add_f32 v8, 1.0, v8
  v_rcp_f32 v8, v8
  s_nop 0
  v_mul_f32 v156, v156, v8
  v_mul_f32 v157, 0x62800000, v157
  v_mul_f32 v8, s46, v157
  v_exp_f32 v8, v8
  s_nop 0
  v_add_f32 v8, 1.0, v8
  v_rcp_f32 v8, v8
  s_nop 0
  v_mul_f32 v157, v157, v8
  v_cvt_pk_bf16_f32 v8, v156, v157
  v_lshlrev_b32 v156, 16, v8
  v_and_b32 v157, s60, v8
  v_lshlrev_b32 v158, 16, v175
  v_and_b32 v159, s60, v175
  v_mul_f32 v158, 0x62800000, v158
  v_mul_f32 v8, s46, v158
  v_exp_f32 v8, v8
  s_nop 0
  v_add_f32 v8, 1.0, v8
  v_rcp_f32 v8, v8
  s_nop 0
  v_mul_f32 v158, v158, v8
  v_mul_f32 v159, 0x62800000, v159
  v_mul_f32 v8, s46, v159
  v_exp_f32 v8, v8
  s_nop 0
  v_add_f32 v8, 1.0, v8
  v_rcp_f32 v8, v8
  s_nop 0
  v_mul_f32 v159, v159, v8
  v_cvt_pk_bf16_f32 v8, v158, v159
  v_lshlrev_b32 v158, 16, v8
  v_and_b32 v159, s60, v8
  s_nop 1
  s_branch K2_BACK0b
K2_PRa:
  s_add_u32 s98, s98, s99
  s_add_u32 s100, s100, 1
  s_setprio 2
  s_cmp_eq_u32 s100, 1
  s_cbranch_scc1 K2_PBa
  s_setprio 1
  s_cmp_eq_u32 s100, 2
  s_cbranch_scc1 K2_PBa
  s_setprio 0
  s_branch K2_PBa
K2_SLOW1a:
  s_waitcnt lgkmcnt(0)
  v_lshlrev_b32 v128, 16, v160
  v_and_b32 v129, s60, v160
  v_mul_f32 v128, 0x62800000, v128
  v_mul_f32 v8, s46, v128
  v_exp_f32 v8, v8
  s_nop 0
  v_add_f32 v8, 1.0, v8
  v_rcp_f32 v8, v8
  s_nop 0
  v_mul_f32 v128, v128, v8
  v_mul_f32 v129, 0x62800000, v129
  v_mul_f32 v8, s46, v129
  v_exp_f32 v8, v8
  s_nop 0
  v_add_f32 v8, 1.0, v8
  v_rcp_f32 v8, v8
  s_nop 0
  v_mul_f32 v129, v129, v8
  v_cvt_pk_bf16_f32 v8, v128, v129
  v_lshlrev_b32 v128, 16, v8
  v_and_b32 v129, s60, v8
  v_lshlrev_b32 v130, 16, v161
  v_and_b32 v131, s60, v161
  v_mul_f32 v130, 0x62800000, v130
  v_mul_f32 v8, s46, v130
  v_exp_f32 v8, v8
  s_nop 0
  v_add_f32 v8, 1.0, v8
  v_rcp_f32 v8, v8
  s_nop 0
  v_mul_f32 v130, v130, v8
  v_mul_f32 v131, 0x62800000, v131
  v_mul_f32 v8, s46, v131
  v_exp_f32 v8, v8
  s_nop 0
  v_add_f32 v8, 1.0, v8
  v_rcp_f32 v8, v8
  s_nop 0
  v_mul_f32 v131, v131, v8
  v_cvt_pk_bf16_f32 v8, v130, v131
  v_lshlrev_b32 v130, 16, v8
  v_and_b32 v131, s60, v8
  v_lshlrev_b32 v132, 16, v162
  v_and_b32 v133, s60, v162
  v_mul_f32 v132, 0x62800000, v132
  v_mul_f32 v8, s46, v132
  v_exp_f32 v8, v8
  s_nop 0
  v_add_f32 v8, 1.0, v8
  v_rcp_f32 v8, v8
  s_nop 0
  v_mul_f32 v132, v132, v8
  v_mul_f32 v133, 0x62800000, v133
  v_mul_f32 v8, s46, v133
  v_exp_f32 v8, v8
  s_nop 0
  v_add_f32 v8, 1.0, v8
  v_rcp_f32 v8, v8
  s_nop 0
  v_mul_f32 v133, v133, v8
  v_cvt_pk_bf16_f32 v8, v132, v133
  v_lshlrev_b32 v132, 16, v8
  v_and_b32 v133, s60, v8
  v_lshlrev_b32 v134, 16, v163
  v_and_b32 v135, s60, v163
  v_mul_f32 v134, 0x62800000, v134
  v_mul_f32 v8, s46, v134
  v_exp_f32 v8, v8
  s_nop 0
  v_add_f32 v8, 1.0, v8
  v_rcp_f32 v8, v8
  s_nop 0
  v_mul_f32 v134, v134, v8
  v_mul_f32 v135, 0x62800000, v135
  v_mul_f32 v8, s46, v135
  v_exp_f32 v8, v8
  s_nop 0
  v_add_f32 v8, 1.0, v8
  v_rcp_f32 v8, v8
  s_nop 0
  v_mul_f32 v135, v135, v8
  v_cvt_pk_bf16_f32 v8, v134, v135
  v_lshlrev_b32 v134, 16, v8
  v_and_b32 v135, s60, v8
  v_lshlrev_b32 v136, 16, v164
  v_and_b32 v137, s60, v164
  v_mul_f32 v136, 0x62800000, v136
  v_mul_f32 v8, s46, v136
  v_exp_f32 v8, v8
  s_nop 0
  v_add_f32 v8, 1.0, v8
  v_rcp_f32 v8, v8
  s_nop 0
  v_mul_f32 v136, v136, v8
  v_mul_f32 v137, 0x62800000, v137
  v_mul_f32 v8, s46, v137
  v_exp_f32 v8, v8
  s_nop 0
  v_add_f32 v8, 1.0, v8
  v_rcp_f32 v8, v8
  s_nop 0
  v_mul_f32 v137, v137, v8
  v_cvt_pk_bf16_f32 v8, v136, v137
  v_lshlrev_b32 v136, 16, v8
  v_and_b32 v137, s60, v8
  v_lshlrev_b32 v138, 16, v165
  v_and_b32 v139, s60, v165
  v_mul_f32 v138, 0x62800000, v138
  v_mul_f32 v8, s46, v138
  v_exp_f32 v8, v8
  s_nop 0
  v_add_f32 v8, 1.0, v8
  v_rcp_f32 v8, v8
  s_nop 0
  v_mul_f32 v138, v138, v8
  v_mul_f32 v139, 0x62800000, v139
  v_mul_f32 v8, s46, v139
  v_exp_f32 v8, v8
  s_nop 0
  v_add_f32 v8, 1.0, v8
  v_rcp_f32 v8, v8
  s_nop 0
  v_mul_f32 v139, v139, v8
  v_cvt_pk_bf16_f32 v8, v138, v139
  v_lshlrev_b32 v138, 16, v8
  v_and_b32 v139, s60, v8
  v_lshlrev_b32 v140, 16, v166
  v_and_b32 v141, s60, v166
  v_mul_f32 v140, 0x62800000, v140
  v_mul_f32 v8, s46, v140
  v_exp_f32 v8, v8
  s_nop 0
  v_add_f32 v8, 1.0, v8
  v_rcp_f32 v8, v8
  s_nop 0
  v_mul_f32 v140, v140, v8
  v_mul_f32 v141, 0x62800000, v141
  v_mul_f32 v8, s46, v141
  v_exp_f32 v8, v8
  s_nop 0
  v_add_f32 v8, 1.0, v8
  v_rcp_f32 v8, v8
  s_nop 0
  v_mul_f32 v141, v141, v8
  v_cvt_pk_bf16_f32 v8, v140, v141
  v_lshlrev_b32 v140, 16, v8
  v_and_b32 v141, s60, v8
  v_lshlrev_b32 v142, 16, v167
  v_and_b32 v143, s60, v167
  v_mul_f32 v142, 0x62800000, v142
  v_mul_f32 v8, s46, v142
  v_exp_f32 v8, v8
  s_nop 0
  v_add_f32 v8, 1.0, v8
  v_rcp_f32 v8, v8
  s_nop 0
  v_mul_f32 v142, v142, v8
  v_mul_f32 v143, 0x62800000, v143
  v_mul_f32 v8, s46, v143
  v_exp_f32 v8, v8
  s_nop 0
  v_add_f32 v8, 1.0, v8
  v_rcp_f32 v8, v8
  s_nop 0
  v_mul_f32 v143, v143, v8
  v_cvt_pk_bf16_f32 v8, v142, v143
  v_lshlrev_b32 v142, 16, v8
  v_and_b32 v143, s60, v8
  s_nop 1
  s_branch K2_BACK1a
K2_SLOW1b:
  s_waitcnt lgkmcnt(0)
  v_lshlrev_b32 v144, 16, v168
  v_and_b32 v145, s60, v168
  v_mul_f32 v144, 0x62800000, v144
  v_mul_f32 v8, s46, v144
  v_exp_f32 v8, v8
  s_nop 0
  v_add_f32 v8, 1.0, v8
  v_rcp_f32 v8, v8
  s_nop 0
  v_mul_f32 v144, v144, v8
  v_mul_f32 v145, 0x62800000, v145
  v_mul_f32 v8, s46, v145
  v_exp_f32 v8, v8
  s_nop 0
  v_add_f32 v8, 1.0, v8
  v_rcp_f32 v8, v8
  s_nop 0
  v_mul_f32 v145, v145, v8
  v_cvt_pk_bf16_f32 v8, v144, v145
  v_lshlrev_b32 v144, 16, v8
  v_and_b32 v145, s60, v8
  v_lshlrev_b32 v146, 16, v169
  v_and_b32 v147, s60, v169
  v_mul_f32 v146, 0x62800000, v146
  v_mul_f32 v8, s46, v146
  v_exp_f32 v8, v8
  s_nop 0
  v_add_f32 v8, 1.0, v8
  v_rcp_f32 v8, v8
  s_nop 0
  v_mul_f32 v146, v146, v8
  v_mul_f32 v147, 0x62800000, v147
  v_mul_f32 v8, s46, v147
  v_exp_f32 v8, v8
  s_nop 0
  v_add_f32 v8, 1.0, v8
  v_rcp_f32 v8, v8
  s_nop 0
  v_mul_f32 v147, v147, v8
  v_cvt_pk_bf16_f32 v8, v146, v147
  v_lshlrev_b32 v146, 16, v8
  v_and_b32 v147, s60, v8
  v_lshlrev_b32 v148, 16, v170
  v_and_b32 v149, s60, v170
  v_mul_f32 v148, 0x62800000, v148
  v_mul_f32 v8, s46, v148
  v_exp_f32 v8, v8
  s_nop 0
  v_add_f32 v8, 1.0, v8
  v_rcp_f32 v8, v8
  s_nop 0
  v_mul_f32 v148, v148, v8
  v_mul_f32 v149, 0x62800000, v149
  v_mul_f32 v8, s46, v149
  v_exp_f32 v8, v8
  s_nop 0
  v_add_f32 v8, 1.0, v8
  v_rcp_f32 v8, v8
  s_nop 0
  v_mul_f32 v149, v149, v8
  v_cvt_pk_bf16_f32 v8, v148, v149
  v_lshlrev_b32 v148, 16, v8
  v_and_b32 v149, s60, v8
  v_lshlrev_b32 v150, 16, v171
  v_and_b32 v151, s60, v171
  v_mul_f32 v150, 0x62800000, v150
  v_mul_f32 v8, s46, v150
  v_exp_f32 v8, v8
  s_nop 0
  v_add_f32 v8, 1.0, v8
  v_rcp_f32 v8, v8
  s_nop 0
  v_mul_f32 v150, v150, v8
  v_mul_f32 v151, 0x62800000, v151
  v_mul_f32 v8, s46, v151
  v_exp_f32 v8, v8
  s_nop 0
  v_add_f32 v8, 1.0, v8
  v_rcp_f32 v8, v8
  s_nop 0
  v_mul_f32 v151, v151, v8
  v_cvt_pk_bf16_f32 v8, v150, v151
  v_lshlrev_b32 v150, 16, v8
  v_and_b32 v151, s60, v8
  v_lshlrev_b32 v152, 16, v172
  v_and_b32 v153, s60, v172
  v_mul_f32 v152, 0x62800000, v152
  v_mul_f32 v8, s46, v152
  v_exp_f32 v8, v8
  s_nop 0
  v_add_f32 v8, 1.0, v8
  v_rcp_f32 v8, v8
  s_nop 0
  v_mul_f32 v152, v152, v8
  v_mul_f32 v153, 0x62800000, v153
  v_mul_f32 v8, s46, v153
  v_exp_f32 v8, v8
  s_nop 0
  v_add_f32 v8, 1.0, v8
  v_rcp_f32 v8, v8
  s_nop 0
  v_mul_f32 v153, v153, v8
  v_cvt_pk_bf16_f32 v8, v152, v153
  v_lshlrev_b32 v152, 16, v8
  v_and_b32 v153, s60, v8
  v_lshlrev_b32 v154, 16, v173
  v_and_b32 v155, s60, v173
  v_mul_f32 v154, 0x62800000, v154
  v_mul_f32 v8, s46, v154
  v_exp_f32 v8, v8
  s_nop 0
  v_add_f32 v8, 1.0, v8
  v_rcp_f32 v8, v8
  s_nop 0
  v_mul_f32 v154, v154, v8
  v_mul_f32 v155, 0x62800000, v155
  v_mul_f32 v8, s46, v155
  v_exp_f32 v8, v8
  s_nop 0
  v_add_f32 v8, 1.0, v8
  v_rcp_f32 v8, v8
  s_nop 0
  v_mul_f32 v155, v155, v8
  v_cvt_pk_bf16_f32 v8, v154, v155
  v_lshlrev_b32 v154, 16, v8
  v_and_b32 v155, s60, v8
  v_lshlrev_b32 v156, 16, v174
  v_and_b32 v157, s60, v174
  v_mul_f32 v156, 0x62800000, v156
  v_mul_f32 v8, s46, v156
  v_exp_f32 v8, v8
  s_nop 0
  v_add_f32 v8, 1.0, v8
  v_rcp_f32 v8, v8
  s_nop 0
  v_mul_f32 v156, v156, v8
  v_mul_f32 v157, 0x62800000, v157
  v_mul_f32 v8, s46, v157
  v_exp_f32 v8, v8
  s_nop 0
  v_add_f32 v8, 1.0, v8
  v_rcp_f32 v8, v8
  s_nop 0
  v_mul_f32 v157, v157, v8
  v_cvt_pk_bf16_f32 v8, v156, v157
  v_lshlrev_b32 v156, 16, v8
  v_and_b32 v157, s60, v8
  v_lshlrev_b32 v158, 16, v175
  v_and_b32 v159, s60, v175
  v_mul_f32 v158, 0x62800000, v158
  v_mul_f32 v8, s46, v158
  v_exp_f32 v8, v8
  s_nop 0
  v_add_f32 v8, 1.0, v8
  v_rcp_f32 v8, v8
  s_nop 0
  v_mul_f32 v158, v158, v8
  v_mul_f32 v159, 0x62800000, v159
  v_mul_f32 v8, s46, v159
  v_exp_f32 v8, v8
  s_nop 0
  v_add_f32 v8, 1.0, v8
  v_rcp_f32 v8, v8
  s_nop 0
  v_mul_f32 v159, v159, v8
  v_cvt_pk_bf16_f32 v8, v158, v159
  v_lshlrev_b32 v158, 16, v8
  v_and_b32 v159, s60, v8
  s_nop 1
  s_branch K2_BACK1b
K2_PRb:
  s_add_u32 s98, s98, s99
  s_add_u32 s100, s100, 1
  s_setprio 2
  s_cmp_eq_u32 s100, 1
  s_cbranch_scc1 K2_PBb
  s_setprio 1
  s_cmp_eq_u32 s100, 2
  s_cbranch_scc1 K2_PBb
  s_setprio 0
  s_branch K2_PBb
K2_SLOW0c:
  s_waitcnt lgkmcnt(0)
  v_lshlrev_b32 v144, 16, v168
  v_and_b32 v145, s60, v168
  v_mul_f32 v144, 0x62800000, v144
  v_mul_f32 v8, s46, v144
  v_exp_f32 v8, v8
  s_nop 0
  v_add_f32 v8, 1.0, v8
  v_rcp_f32 v8, v8
  s_nop 0
  v_mul_f32 v144, v144, v8
  v_mul_f32 v145, 0x62800000, v145
  v_mul_f32 v8, s46, v145
  v_exp_f32 v8, v8
  s_nop 0
  v_add_f32 v8, 1.0, v8
  v_rcp_f32 v8, v8
  s_nop 0
  v_mul_f32 v145, v145, v8
  v_cvt_pk_bf16_f32 v8, v144, v145
  v_lshlrev_b32 v144, 16, v8
  v_and_b32 v145, s60, v8
  v_lshlrev_b32 v146, 16, v169
  v_and_b32 v147, s60, v169
  v_mul_f32 v146, 0x62800000, v146
  v_mul_f32 v8, s46, v146
  v_exp_f32 v8, v8
  s_nop 0
  v_add_f32 v8, 1.0, v8
  v_rcp_f32 v8, v8
  s_nop 0
  v_mul_f32 v146, v146, v8
  v_mul_f32 v147, 0x62800000, v147
  v_mul_f32 v8, s46, v147
  v_exp_f32 v8, v8
  s_nop 0
  v_add_f32 v8, 1.0, v8
  v_rcp_f32 v8, v8
  s_nop 0
  v_mul_f32 v147, v147, v8
  v_cvt_pk_bf16_f32 v8, v146, v147
  v_lshlrev_b32 v146, 16, v8
  v_and_b32 v147, s60, v8
  v_lshlrev_b32 v148, 16, v170
  v_and_b32 v149, s60, v170
  v_mul_f32 v148, 0x62800000, v148
  v_mul_f32 v8, s46, v148
  v_exp_f32 v8, v8
  s_nop 0
  v_add_f32 v8, 1.0, v8
  v_rcp_f32 v8, v8
  s_nop 0
  v_mul_f32 v148, v148, v8
  v_mul_f32 v149, 0x62800000, v149
  v_mul_f32 v8, s46, v149
  v_exp_f32 v8, v8
  s_nop 0
  v_add_f32 v8, 1.0, v8
  v_rcp_f32 v8, v8
  s_nop 0
  v_mul_f32 v149, v149, v8
  v_cvt_pk_bf16_f32 v8, v148, v149
  v_lshlrev_b32 v148, 16, v8
  v_and_b32 v149, s60, v8
  v_lshlrev_b32 v150, 16, v171
  v_and_b32 v151, s60, v171
  v_mul_f32 v150, 0x62800000, v150
  v_mul_f32 v8, s46, v150
  v_exp_f32 v8, v8
  s_nop 0
  v_add_f32 v8, 1.0, v8
  v_rcp_f32 v8, v8
  s_nop 0
  v_mul_f32 v150, v150, v8
  v_mul_f32 v151, 0x62800000, v151
  v_mul_f32 v8, s46, v151
  v_exp_f32 v8, v8
  s_nop 0
  v_add_f32 v8, 1.0, v8
  v_rcp_f32 v8, v8
  s_nop 0
  v_mul_f32 v151, v151, v8
  v_cvt_pk_bf16_f32 v8, v150, v151
  v_lshlrev_b32 v150, 16, v8
  v_and_b32 v151, s60, v8
  v_lshlrev_b32 v152, 16, v172
  v_and_b32 v153, s60, v172
  v_mul_f32 v152, 0x62800000, v152
  v_mul_f32 v8, s46, v152
  v_exp_f32 v8, v8
  s_nop 0
  v_add_f32 v8, 1.0, v8
  v_rcp_f32 v8, v8
  s_nop 0
  v_mul_f32 v152, v152, v8
  v_mul_f32 v153, 0x62800000, v153
  v_mul_f32 v8, s46, v153
  v_exp_f32 v8, v8
  s_nop 0
  v_add_f32 v8, 1.0, v8
  v_rcp_f32 v8, v8
  s_nop 0
  v_mul_f32 v153, v153, v8
  v_cvt_pk_bf16_f32 v8, v152, v153
  v_lshlrev_b32 v152, 16, v8
  v_and_b32 v153, s60, v8
  v_lshlrev_b32 v154, 16, v173
  v_and_b32 v155, s60, v173
  v_mul_f32 v154, 0x62800000, v154
  v_mul_f32 v8, s46, v154
  v_exp_f32 v8, v8
  s_nop 0
  v_add_f32 v8, 1.0, v8
  v_rcp_f32 v8, v8
  s_nop 0
  v_mul_f32 v154, v154, v8
  v_mul_f32 v155, 0x62800000, v155
  v_mul_f32 v8, s46, v155
  v_exp_f32 v8, v8
  s_nop 0
  v_add_f32 v8, 1.0, v8
  v_rcp_f32 v8, v8
  s_nop 0
  v_mul_f32 v155, v155, v8
  v_cvt_pk_bf16_f32 v8, v154, v155
  v_lshlrev_b32 v154, 16, v8
  v_and_b32 v155, s60, v8
  v_lshlrev_b32 v156, 16, v174
  v_and_b32 v157, s60, v174
  v_mul_f32 v156, 0x62800000, v156
  v_mul_f32 v8, s46, v156
  v_exp_f32 v8, v8
  s_nop 0
  v_add_f32 v8, 1.0, v8
  v_rcp_f32 v8, v8
  s_nop 0
  v_mul_f32 v156, v156, v8
  v_mul_f32 v157, 0x62800000, v157
  v_mul_f32 v8, s46, v157
  v_exp_f32 v8, v8
  s_nop 0
  v_add_f32 v8, 1.0, v8
  v_rcp_f32 v8, v8
  s_nop 0
  v_mul_f32 v157, v157, v8
  v_cvt_pk_bf16_f32 v8, v156, v157
  v_lshlrev_b32 v156, 16, v8
  v_and_b32 v157, s60, v8
  v_lshlrev_b32 v158, 16, v175
  v_and_b32 v159, s60, v175
  v_mul_f32 v158, 0x62800000, v158
  v_mul_f32 v8, s46, v158
  v_exp_f32 v8, v8
  s_nop 0
  v_add_f32 v8, 1.0, v8
  v_rcp_f32 v8, v8
  s_nop 0
  v_mul_f32 v158, v158, v8
  v_mul_f32 v159, 0x62800000, v159
  v_mul_f32 v8, s46, v159
  v_exp_f32 v8, v8
  s_nop 0
  v_add_f32 v8, 1.0, v8
  v_rcp_f32 v8, v8
  s_nop 0
  v_mul_f32 v159, v159, v8
  v_cvt_pk_bf16_f32 v8, v158, v159
  v_lshlrev_b32 v158, 16, v8
  v_and_b32 v159, s60, v8
  s_nop 1
  s_branch K2_BACK0c
K2_SLOW0ce0:
  s_waitcnt lgkmcnt(0)
  v_lshlrev_b32 v128, 16, v96
  v_and_b32 v129, s60, v96
  v_mul_f32 v128, 0x62800000, v128
  v_mul_f32 v8, s46, v128
  v_exp_f32 v8, v8
  s_nop 0
  v_add_f32 v8, 1.0, v8
  v_rcp_f32 v8, v8
  s_nop 0
  v_mul_f32 v128, v128, v8
  v_mul_f32 v129, 0x62800000, v129
  v_mul_f32 v8, s46, v129
  v_exp_f32 v8, v8
  s_nop 0
  v_add_f32 v8, 1.0, v8
  v_rcp_f32 v8, v8
  s_nop 0
  v_mul_f32 v129, v129, v8
  v_cvt_pk_bf16_f32 v8, v128, v129
  v_lshlrev_b32 v128, 16, v8
  v_and_b32 v129, s60, v8
  v_lshlrev_b32 v130, 16, v97
  v_and_b32 v131, s60, v97
  v_mul_f32 v130, 0x62800000, v130
  v_mul_f32 v8, s46, v130
  v_exp_f32 v8, v8
  s_nop 0
  v_add_f32 v8, 1.0, v8
  v_rcp_f32 v8, v8
  s_nop 0
  v_mul_f32 v130, v130, v8
  v_mul_f32 v131, 0x62800000, v131
  v_mul_f32 v8, s46, v131
  v_exp_f32 v8, v8
  s_nop 0
  v_add_f32 v8, 1.0, v8
  v_rcp_f32 v8, v8
  s_nop 0
  v_mul_f32 v131, v131, v8
  v_cvt_pk_bf16_f32 v8, v130, v131
  v_lshlrev_b32 v130, 16, v8
  v_and_b32 v131, s60, v8
  v_lshlrev_b32 v132, 16, v98
  v_and_b32 v133, s60, v98
  v_mul_f32 v132, 0x62800000, v132
  v_mul_f32 v8, s46, v132
  v_exp_f32 v8, v8
  s_nop 0
  v_add_f32 v8, 1.0, v8
  v_rcp_f32 v8, v8
  s_nop 0
  v_mul_f32 v132, v132, v8
  v_mul_f32 v133, 0x62800000, v133
  v_mul_f32 v8, s46, v133
  v_exp_f32 v8, v8
  s_nop 0
  v_add_f32 v8, 1.0, v8
  v_rcp_f32 v8, v8
  s_nop 0
  v_mul_f32 v133, v133, v8
  v_cvt_pk_bf16_f32 v8, v132, v133
  v_lshlrev_b32 v132, 16, v8
  v_and_b32 v133, s60, v8
  v_lshlrev_b32 v134, 16, v99
  v_and_b32 v135, s60, v99
  v_mul_f32 v134, 0x62800000, v134
  v_mul_f32 v8, s46, v134
  v_exp_f32 v8, v8
  s_nop 0
  v_add_f32 v8, 1.0, v8
  v_rcp_f32 v8, v8
  s_nop 0
  v_mul_f32 v134, v134, v8
  v_mul_f32 v135, 0x62800000, v135
  v_mul_f32 v8, s46, v135
  v_exp_f32 v8, v8
  s_nop 0
  v_add_f32 v8, 1.0, v8
  v_rcp_f32 v8, v8
  s_nop 0
  v_mul_f32 v135, v135, v8
  v_cvt_pk_bf16_f32 v8, v134, v135
  v_lshlrev_b32 v134, 16, v8
  v_and_b32 v135, s60, v8
  v_lshlrev_b32 v136, 16, v100
  v_and_b32 v137, s60, v100
  v_mul_f32 v136, 0x62800000, v136
  v_mul_f32 v8, s46, v136
  v_exp_f32 v8, v8
  s_nop 0
  v_add_f32 v8, 1.0, v8
  v_rcp_f32 v8, v8
  s_nop 0
  v_mul_f32 v136, v136, v8
  v_mul_f32 v137, 0x62800000, v137
  v_mul_f32 v8, s46, v137
  v_exp_f32 v8, v8
  s_nop 0
  v_add_f32 v8, 1.0, v8
  v_rcp_f32 v8, v8
  s_nop 0
  v_mul_f32 v137, v137, v8
  v_cvt_pk_bf16_f32 v8, v136, v137
  v_lshlrev_b32 v136, 16, v8
  v_and_b32 v137, s60, v8
  v_lshlrev_b32 v138, 16, v101
  v_and_b32 v139, s60, v101
  v_mul_f32 v138, 0x62800000, v138
  v_mul_f32 v8, s46, v138
  v_exp_f32 v8, v8
  s_nop 0
  v_add_f32 v8, 1.0, v8
  v_rcp_f32 v8, v8
  s_nop 0
  v_mul_f32 v138, v138, v8
  v_mul_f32 v139, 0x62800000, v139
  v_mul_f32 v8, s46, v139
  v_exp_f32 v8, v8
  s_nop 0
  v_add_f32 v8, 1.0, v8
  v_rcp_f32 v8, v8
  s_nop 0
  v_mul_f32 v139, v139, v8
  v_cvt_pk_bf16_f32 v8, v138, v139
  v_lshlrev_b32 v138, 16, v8
  v_and_b32 v139, s60, v8
  v_lshlrev_b32 v140, 16, v102
  v_and_b32 v141, s60, v102
  v_mul_f32 v140, 0x62800000, v140
  v_mul_f32 v8, s46, v140
  v_exp_f32 v8, v8
  s_nop 0
  v_add_f32 v8, 1.0, v8
  v_rcp_f32 v8, v8
  s_nop 0
  v_mul_f32 v140, v140, v8
  v_mul_f32 v141, 0x62800000, v141
  v_mul_f32 v8, s46, v141
  v_exp_f32 v8, v8
  s_nop 0
  v_add_f32 v8, 1.0, v8
  v_rcp_f32 v8, v8
  s_nop 0
  v_mul_f32 v141, v141, v8
  v_cvt_pk_bf16_f32 v8, v140, v141
  v_lshlrev_b32 v140, 16, v8
  v_and_b32 v141, s60, v8
  v_lshlrev_b32 v142, 16, v103
  v_and_b32 v143, s60, v103
  v_mul_f32 v142, 0x62800000, v142
  v_mul_f32 v8, s46, v142
  v_exp_f32 v8, v8
  s_nop 0
  v_add_f32 v8, 1.0, v8
  v_rcp_f32 v8, v8
  s_nop 0
  v_mul_f32 v142, v142, v8
  v_mul_f32 v143, 0x62800000, v143
  v_mul_f32 v8, s46, v143
  v_exp_f32 v8, v8
  s_nop 0
  v_add_f32 v8, 1.0, v8
  v_rcp_f32 v8, v8
  s_nop 0
  v_mul_f32 v143, v143, v8
  v_cvt_pk_bf16_f32 v8, v142, v143
  v_lshlrev_b32 v142, 16, v8
  v_and_b32 v143, s60, v8
  s_nop 1
  s_branch K2_BACK0ce0
K2_SLOW0ce1:
  s_waitcnt lgkmcnt(0)
  v_lshlrev_b32 v144, 16, v104
  v_and_b32 v145, s60, v104
  v_mul_f32 v144, 0x62800000, v144
  v_mul_f32 v8, s46, v144
  v_exp_f32 v8, v8
  s_nop 0
  v_add_f32 v8, 1.0, v8
  v_rcp_f32 v8, v8
  s_nop 0
  v_mul_f32 v144, v144, v8
  v_mul_f32 v145, 0x62800000, v145
  v_mul_f32 v8, s46, v145
  v_exp_f32 v8, v8
  s_nop 0
  v_add_f32 v8, 1.0, v8
  v_rcp_f32 v8, v8
  s_nop 0
  v_mul_f32 v145, v145, v8
  v_cvt_pk_bf16_f32 v8, v144, v145
  v_lshlrev_b32 v144, 16, v8
  v_and_b32 v145, s60, v8
  v_lshlrev_b32 v146, 16, v105
  v_and_b32 v147, s60, v105
  v_mul_f32 v146, 0x62800000, v146
  v_mul_f32 v8, s46, v146
  v_exp_f32 v8, v8
  s_nop 0
  v_add_f32 v8, 1.0, v8
  v_rcp_f32 v8, v8
  s_nop 0
  v_mul_f32 v146, v146, v8
  v_mul_f32 v147, 0x62800000, v147
  v_mul_f32 v8, s46, v147
  v_exp_f32 v8, v8
  s_nop 0
  v_add_f32 v8, 1.0, v8
  v_rcp_f32 v8, v8
  s_nop 0
  v_mul_f32 v147, v147, v8
  v_cvt_pk_bf16_f32 v8, v146, v147
  v_lshlrev_b32 v146, 16, v8
  v_and_b32 v147, s60, v8
  v_lshlrev_b32 v148, 16, v106
  v_and_b32 v149, s60, v106
  v_mul_f32 v148, 0x62800000, v148
  v_mul_f32 v8, s46, v148
  v_exp_f32 v8, v8
  s_nop 0
  v_add_f32 v8, 1.0, v8
  v_rcp_f32 v8, v8
  s_nop 0
  v_mul_f32 v148, v148, v8
  v_mul_f32 v149, 0x62800000, v149
  v_mul_f32 v8, s46, v149
  v_exp_f32 v8, v8
  s_nop 0
  v_add_f32 v8, 1.0, v8
  v_rcp_f32 v8, v8
  s_nop 0
  v_mul_f32 v149, v149, v8
  v_cvt_pk_bf16_f32 v8, v148, v149
  v_lshlrev_b32 v148, 16, v8
  v_and_b32 v149, s60, v8
  v_lshlrev_b32 v150, 16, v107
  v_and_b32 v151, s60, v107
  v_mul_f32 v150, 0x62800000, v150
  v_mul_f32 v8, s46, v150
  v_exp_f32 v8, v8
  s_nop 0
  v_add_f32 v8, 1.0, v8
  v_rcp_f32 v8, v8
  s_nop 0
  v_mul_f32 v150, v150, v8
  v_mul_f32 v151, 0x62800000, v151
  v_mul_f32 v8, s46, v151
  v_exp_f32 v8, v8
  s_nop 0
  v_add_f32 v8, 1.0, v8
  v_rcp_f32 v8, v8
  s_nop 0
  v_mul_f32 v151, v151, v8
  v_cvt_pk_bf16_f32 v8, v150, v151
  v_lshlrev_b32 v150, 16, v8
  v_and_b32 v151, s60, v8
  v_lshlrev_b32 v152, 16, v108
  v_and_b32 v153, s60, v108
  v_mul_f32 v152, 0x62800000, v152
  v_mul_f32 v8, s46, v152
  v_exp_f32 v8, v8
  s_nop 0
  v_add_f32 v8, 1.0, v8
  v_rcp_f32 v8, v8
  s_nop 0
  v_mul_f32 v152, v152, v8
  v_mul_f32 v153, 0x62800000, v153
  v_mul_f32 v8, s46, v153
  v_exp_f32 v8, v8
  s_nop 0
  v_add_f32 v8, 1.0, v8
  v_rcp_f32 v8, v8
  s_nop 0
  v_mul_f32 v153, v153, v8
  v_cvt_pk_bf16_f32 v8, v152, v153
  v_lshlrev_b32 v152, 16, v8
  v_and_b32 v153, s60, v8
  v_lshlrev_b32 v154, 16, v109
  v_and_b32 v155, s60, v109
  v_mul_f32 v154, 0x62800000, v154
  v_mul_f32 v8, s46, v154
  v_exp_f32 v8, v8
  s_nop 0
  v_add_f32 v8, 1.0, v8
  v_rcp_f32 v8, v8
  s_nop 0
  v_mul_f32 v154, v154, v8
  v_mul_f32 v155, 0x62800000, v155
  v_mul_f32 v8, s46, v155
  v_exp_f32 v8, v8
  s_nop 0
  v_add_f32 v8, 1.0, v8
  v_rcp_f32 v8, v8
  s_nop 0
  v_mul_f32 v155, v155, v8
  v_cvt_pk_bf16_f32 v8, v154, v155
  v_lshlrev_b32 v154, 16, v8
  v_and_b32 v155, s60, v8
  v_lshlrev_b32 v156, 16, v110
  v_and_b32 v157, s60, v110
  v_mul_f32 v156, 0x62800000, v156
  v_mul_f32 v8, s46, v156
  v_exp_f32 v8, v8
  s_nop 0
  v_add_f32 v8, 1.0, v8
  v_rcp_f32 v8, v8
  s_nop 0
  v_mul_f32 v156, v156, v8
  v_mul_f32 v157, 0x62800000, v157
  v_mul_f32 v8, s46, v157
  v_exp_f32 v8, v8
  s_nop 0
  v_add_f32 v8, 1.0, v8
  v_rcp_f32 v8, v8
  s_nop 0
  v_mul_f32 v157, v157, v8
  v_cvt_pk_bf16_f32 v8, v156, v157
  v_lshlrev_b32 v156, 16, v8
  v_and_b32 v157, s60, v8
  v_lshlrev_b32 v158, 16, v111
  v_and_b32 v159, s60, v111
  v_mul_f32 v158, 0x62800000, v158
  v_mul_f32 v8, s46, v158
  v_exp_f32 v8, v8
  s_nop 0
  v_add_f32 v8, 1.0, v8
  v_rcp_f32 v8, v8
  s_nop 0
  v_mul_f32 v158, v158, v8
  v_mul_f32 v159, 0x62800000, v159
  v_mul_f32 v8, s46, v159
  v_exp_f32 v8, v8
  s_nop 0
  v_add_f32 v8, 1.0, v8
  v_rcp_f32 v8, v8
  s_nop 0
  v_mul_f32 v159, v159, v8
  v_cvt_pk_bf16_f32 v8, v158, v159
  v_lshlrev_b32 v158, 16, v8
  v_and_b32 v159, s60, v8
  s_nop 1
  s_branch K2_BACK0ce1
K2_SLOW1c:
  s_waitcnt lgkmcnt(0)
  v_lshlrev_b32 v144, 16, v168
  v_and_b32 v145, s60, v168
  v_mul_f32 v144, 0x62800000, v144
  v_mul_f32 v8, s46, v144
  v_exp_f32 v8, v8
  s_nop 0
  v_add_f32 v8, 1.0, v8
  v_rcp_f32 v8, v8
  s_nop 0
  v_mul_f32 v144, v144, v8
  v_mul_f32 v145, 0x62800000, v145
  v_mul_f32 v8, s46, v145
  v_exp_f32 v8, v8
  s_nop 0
  v_add_f32 v8, 1.0, v8
  v_rcp_f32 v8, v8
  s_nop 0
  v_mul_f32 v145, v145, v8
  v_cvt_pk_bf16_f32 v8, v144, v145
  v_lshlrev_b32 v144, 16, v8
  v_and_b32 v145, s60, v8
  v_lshlrev_b32 v146, 16, v169
  v_and_b32 v147, s60, v169
  v_mul_f32 v146, 0x62800000, v146
  v_mul_f32 v8, s46, v146
  v_exp_f32 v8, v8
  s_nop 0
  v_add_f32 v8, 1.0, v8
  v_rcp_f32 v8, v8
  s_nop 0
  v_mul_f32 v146, v146, v8
  v_mul_f32 v147, 0x62800000, v147
  v_mul_f32 v8, s46, v147
  v_exp_f32 v8, v8
  s_nop 0
  v_add_f32 v8, 1.0, v8
  v_rcp_f32 v8, v8
  s_nop 0
  v_mul_f32 v147, v147, v8
  v_cvt_pk_bf16_f32 v8, v146, v147
  v_lshlrev_b32 v146, 16, v8
  v_and_b32 v147, s60, v8
  v_lshlrev_b32 v148, 16, v170
  v_and_b32 v149, s60, v170
  v_mul_f32 v148, 0x62800000, v148
  v_mul_f32 v8, s46, v148
  v_exp_f32 v8, v8
  s_nop 0
  v_add_f32 v8, 1.0, v8
  v_rcp_f32 v8, v8
  s_nop 0
  v_mul_f32 v148, v148, v8
  v_mul_f32 v149, 0x62800000, v149
  v_mul_f32 v8, s46, v149
  v_exp_f32 v8, v8
  s_nop 0
  v_add_f32 v8, 1.0, v8
  v_rcp_f32 v8, v8
  s_nop 0
  v_mul_f32 v149, v149, v8
  v_cvt_pk_bf16_f32 v8, v148, v149
  v_lshlrev_b32 v148, 16, v8
  v_and_b32 v149, s60, v8
  v_lshlrev_b32 v150, 16, v171
  v_and_b32 v151, s60, v171
  v_mul_f32 v150, 0x62800000, v150
  v_mul_f32 v8, s46, v150
  v_exp_f32 v8, v8
  s_nop 0
  v_add_f32 v8, 1.0, v8
  v_rcp_f32 v8, v8
  s_nop 0
  v_mul_f32 v150, v150, v8
  v_mul_f32 v151, 0x62800000, v151
  v_mul_f32 v8, s46, v151
  v_exp_f32 v8, v8
  s_nop 0
  v_add_f32 v8, 1.0, v8
  v_rcp_f32 v8, v8
  s_nop 0
  v_mul_f32 v151, v151, v8
  v_cvt_pk_bf16_f32 v8, v150, v151
  v_lshlrev_b32 v150, 16, v8
  v_and_b32 v151, s60, v8
  v_lshlrev_b32 v152, 16, v172
  v_and_b32 v153, s60, v172
  v_mul_f32 v152, 0x62800000, v152
  v_mul_f32 v8, s46, v152
  v_exp_f32 v8, v8
  s_nop 0
  v_add_f32 v8, 1.0, v8
  v_rcp_f32 v8, v8
  s_nop 0
  v_mul_f32 v152, v152, v8
  v_mul_f32 v153, 0x62800000, v153
  v_mul_f32 v8, s46, v153
  v_exp_f32 v8, v8
  s_nop 0
  v_add_f32 v8, 1.0, v8
  v_rcp_f32 v8, v8
  s_nop 0
  v_mul_f32 v153, v153, v8
  v_cvt_pk_bf16_f32 v8, v152, v153
  v_lshlrev_b32 v152, 16, v8
  v_and_b32 v153, s60, v8
  v_lshlrev_b32 v154, 16, v173
  v_and_b32 v155, s60, v173
  v_mul_f32 v154, 0x62800000, v154
  v_mul_f32 v8, s46, v154
  v_exp_f32 v8, v8
  s_nop 0
  v_add_f32 v8, 1.0, v8
  v_rcp_f32 v8, v8
  s_nop 0
  v_mul_f32 v154, v154, v8
  v_mul_f32 v155, 0x62800000, v155
  v_mul_f32 v8, s46, v155
  v_exp_f32 v8, v8
  s_nop 0
  v_add_f32 v8, 1.0, v8
  v_rcp_f32 v8, v8
  s_nop 0
  v_mul_f32 v155, v155, v8
  v_cvt_pk_bf16_f32 v8, v154, v155
  v_lshlrev_b32 v154, 16, v8
  v_and_b32 v155, s60, v8
  v_lshlrev_b32 v156, 16, v174
  v_and_b32 v157, s60, v174
  v_mul_f32 v156, 0x62800000, v156
  v_mul_f32 v8, s46, v156
  v_exp_f32 v8, v8
  s_nop 0
  v_add_f32 v8, 1.0, v8
  v_rcp_f32 v8, v8
  s_nop 0
  v_mul_f32 v156, v156, v8
  v_mul_f32 v157, 0x62800000, v157
  v_mul_f32 v8, s46, v157
  v_exp_f32 v8, v8
  s_nop 0
  v_add_f32 v8, 1.0, v8
  v_rcp_f32 v8, v8
  s_nop 0
  v_mul_f32 v157, v157, v8
  v_cvt_pk_bf16_f32 v8, v156, v157
  v_lshlrev_b32 v156, 16, v8
  v_and_b32 v157, s60, v8
  v_lshlrev_b32 v158, 16, v175
  v_and_b32 v159, s60, v175
  v_mul_f32 v158, 0x62800000, v158
  v_mul_f32 v8, s46, v158
  v_exp_f32 v8, v8
  s_nop 0
  v_add_f32 v8, 1.0, v8
  v_rcp_f32 v8, v8
  s_nop 0
  v_mul_f32 v158, v158, v8
  v_mul_f32 v159, 0x62800000, v159
  v_mul_f32 v8, s46, v159
  v_exp_f32 v8, v8
  s_nop 0
  v_add_f32 v8, 1.0, v8
  v_rcp_f32 v8, v8
  s_nop 0
  v_mul_f32 v159, v159, v8
  v_cvt_pk_bf16_f32 v8, v158, v159
  v_lshlrev_b32 v158, 16, v8
  v_and_b32 v159, s60, v8
  s_nop 1
  s_branch K2_BACK1c
K2_SLOW1ce0:
  s_waitcnt lgkmcnt(0)
  v_lshlrev_b32 v128, 16, v96
  v_and_b32 v129, s60, v96
  v_mul_f32 v128, 0x62800000, v128
  v_mul_f32 v8, s46, v128
  v_exp_f32 v8, v8
  s_nop 0
  v_add_f32 v8, 1.0, v8
  v_rcp_f32 v8, v8
  s_nop 0
  v_mul_f32 v128, v128, v8
  v_mul_f32 v129, 0x62800000, v129
  v_mul_f32 v8, s46, v129
  v_exp_f32 v8, v8
  s_nop 0
  v_add_f32 v8, 1.0, v8
  v_rcp_f32 v8, v8
  s_nop 0
  v_mul_f32 v129, v129, v8
  v_cvt_pk_bf16_f32 v8, v128, v129
  v_lshlrev_b32 v128, 16, v8
  v_and_b32 v129, s60, v8
  v_lshlrev_b32 v130, 16, v97
  v_and_b32 v131, s60, v97
  v_mul_f32 v130, 0x62800000, v130
  v_mul_f32 v8, s46, v130
  v_exp_f32 v8, v8
  s_nop 0
  v_add_f32 v8, 1.0, v8
  v_rcp_f32 v8, v8
  s_nop 0
  v_mul_f32 v130, v130, v8
  v_mul_f32 v131, 0x62800000, v131
  v_mul_f32 v8, s46, v131
  v_exp_f32 v8, v8
  s_nop 0
  v_add_f32 v8, 1.0, v8
  v_rcp_f32 v8, v8
  s_nop 0
  v_mul_f32 v131, v131, v8
  v_cvt_pk_bf16_f32 v8, v130, v131
  v_lshlrev_b32 v130, 16, v8
  v_and_b32 v131, s60, v8
  v_lshlrev_b32 v132, 16, v98
  v_and_b32 v133, s60, v98
  v_mul_f32 v132, 0x62800000, v132
  v_mul_f32 v8, s46, v132
  v_exp_f32 v8, v8
  s_nop 0
  v_add_f32 v8, 1.0, v8
  v_rcp_f32 v8, v8
  s_nop 0
  v_mul_f32 v132, v132, v8
  v_mul_f32 v133, 0x62800000, v133
  v_mul_f32 v8, s46, v133
  v_exp_f32 v8, v8
  s_nop 0
  v_add_f32 v8, 1.0, v8
  v_rcp_f32 v8, v8
  s_nop 0
  v_mul_f32 v133, v133, v8
  v_cvt_pk_bf16_f32 v8, v132, v133
  v_lshlrev_b32 v132, 16, v8
  v_and_b32 v133, s60, v8
  v_lshlrev_b32 v134, 16, v99
  v_and_b32 v135, s60, v99
  v_mul_f32 v134, 0x62800000, v134
  v_mul_f32 v8, s46, v134
  v_exp_f32 v8, v8
  s_nop 0
  v_add_f32 v8, 1.0, v8
  v_rcp_f32 v8, v8
  s_nop 0
  v_mul_f32 v134, v134, v8
  v_mul_f32 v135, 0x62800000, v135
  v_mul_f32 v8, s46, v135
  v_exp_f32 v8, v8
  s_nop 0
  v_add_f32 v8, 1.0, v8
  v_rcp_f32 v8, v8
  s_nop 0
  v_mul_f32 v135, v135, v8
  v_cvt_pk_bf16_f32 v8, v134, v135
  v_lshlrev_b32 v134, 16, v8
  v_and_b32 v135, s60, v8
  v_lshlrev_b32 v136, 16, v100
  v_and_b32 v137, s60, v100
  v_mul_f32 v136, 0x62800000, v136
  v_mul_f32 v8, s46, v136
  v_exp_f32 v8, v8
  s_nop 0
  v_add_f32 v8, 1.0, v8
  v_rcp_f32 v8, v8
  s_nop 0
  v_mul_f32 v136, v136, v8
  v_mul_f32 v137, 0x62800000, v137
  v_mul_f32 v8, s46, v137
  v_exp_f32 v8, v8
  s_nop 0
  v_add_f32 v8, 1.0, v8
  v_rcp_f32 v8, v8
  s_nop 0
  v_mul_f32 v137, v137, v8
  v_cvt_pk_bf16_f32 v8, v136, v137
  v_lshlrev_b32 v136, 16, v8
  v_and_b32 v137, s60, v8
  v_lshlrev_b32 v138, 16, v101
  v_and_b32 v139, s60, v101
  v_mul_f32 v138, 0x62800000, v138
  v_mul_f32 v8, s46, v138
  v_exp_f32 v8, v8
  s_nop 0
  v_add_f32 v8, 1.0, v8
  v_rcp_f32 v8, v8
  s_nop 0
  v_mul_f32 v138, v138, v8
  v_mul_f32 v139, 0x62800000, v139
  v_mul_f32 v8, s46, v139
  v_exp_f32 v8, v8
  s_nop 0
  v_add_f32 v8, 1.0, v8
  v_rcp_f32 v8, v8
  s_nop 0
  v_mul_f32 v139, v139, v8
  v_cvt_pk_bf16_f32 v8, v138, v139
  v_lshlrev_b32 v138, 16, v8
  v_and_b32 v139, s60, v8
  v_lshlrev_b32 v140, 16, v102
  v_and_b32 v141, s60, v102
  v_mul_f32 v140, 0x62800000, v140
  v_mul_f32 v8, s46, v140
  v_exp_f32 v8, v8
  s_nop 0
  v_add_f32 v8, 1.0, v8
  v_rcp_f32 v8, v8
  s_nop 0
  v_mul_f32 v140, v140, v8
  v_mul_f32 v141, 0x62800000, v141
  v_mul_f32 v8, s46, v141
  v_exp_f32 v8, v8
  s_nop 0
  v_add_f32 v8, 1.0, v8
  v_rcp_f32 v8, v8
  s_nop 0
  v_mul_f32 v141, v141, v8
  v_cvt_pk_bf16_f32 v8, v140, v141
  v_lshlrev_b32 v140, 16, v8
  v_and_b32 v141, s60, v8
  v_lshlrev_b32 v142, 16, v103
  v_and_b32 v143, s60, v103
  v_mul_f32 v142, 0x62800000, v142
  v_mul_f32 v8, s46, v142
  v_exp_f32 v8, v8
  s_nop 0
  v_add_f32 v8, 1.0, v8
  v_rcp_f32 v8, v8
  s_nop 0
  v_mul_f32 v142, v142, v8
  v_mul_f32 v143, 0x62800000, v143
  v_mul_f32 v8, s46, v143
  v_exp_f32 v8, v8
  s_nop 0
  v_add_f32 v8, 1.0, v8
  v_rcp_f32 v8, v8
  s_nop 0
  v_mul_f32 v143, v143, v8
  v_cvt_pk_bf16_f32 v8, v142, v143
  v_lshlrev_b32 v142, 16, v8
  v_and_b32 v143, s60, v8
  s_nop 1
  s_branch K2_BACK1ce0
K2_SLOW1ce1:
  s_waitcnt lgkmcnt(0)
  v_lshlrev_b32 v144, 16, v104
  v_and_b32 v145, s60, v104
  v_mul_f32 v144, 0x62800000, v144
  v_mul_f32 v8, s46, v144
  v_exp_f32 v8, v8
  s_nop 0
  v_add_f32 v8, 1.0, v8
  v_rcp_f32 v8, v8
  s_nop 0
  v_mul_f32 v144, v144, v8
  v_mul_f32 v145, 0x62800000, v145
  v_mul_f32 v8, s46, v145
  v_exp_f32 v8, v8
  s_nop 0
  v_add_f32 v8, 1.0, v8
  v_rcp_f32 v8, v8
  s_nop 0
  v_mul_f32 v145, v145, v8
  v_cvt_pk_bf16_f32 v8, v144, v145
  v_lshlrev_b32 v144, 16, v8
  v_and_b32 v145, s60, v8
  v_lshlrev_b32 v146, 16, v105
  v_and_b32 v147, s60, v105
  v_mul_f32 v146, 0x62800000, v146
  v_mul_f32 v8, s46, v146
  v_exp_f32 v8, v8
  s_nop 0
  v_add_f32 v8, 1.0, v8
  v_rcp_f32 v8, v8
  s_nop 0
  v_mul_f32 v146, v146, v8
  v_mul_f32 v147, 0x62800000, v147
  v_mul_f32 v8, s46, v147
  v_exp_f32 v8, v8
  s_nop 0
  v_add_f32 v8, 1.0, v8
  v_rcp_f32 v8, v8
  s_nop 0
  v_mul_f32 v147, v147, v8
  v_cvt_pk_bf16_f32 v8, v146, v147
  v_lshlrev_b32 v146, 16, v8
  v_and_b32 v147, s60, v8
  v_lshlrev_b32 v148, 16, v106
  v_and_b32 v149, s60, v106
  v_mul_f32 v148, 0x62800000, v148
  v_mul_f32 v8, s46, v148
  v_exp_f32 v8, v8
  s_nop 0
  v_add_f32 v8, 1.0, v8
  v_rcp_f32 v8, v8
  s_nop 0
  v_mul_f32 v148, v148, v8
  v_mul_f32 v149, 0x62800000, v149
  v_mul_f32 v8, s46, v149
  v_exp_f32 v8, v8
  s_nop 0
  v_add_f32 v8, 1.0, v8
  v_rcp_f32 v8, v8
  s_nop 0
  v_mul_f32 v149, v149, v8
  v_cvt_pk_bf16_f32 v8, v148, v149
  v_lshlrev_b32 v148, 16, v8
  v_and_b32 v149, s60, v8
  v_lshlrev_b32 v150, 16, v107
  v_and_b32 v151, s60, v107
  v_mul_f32 v150, 0x62800000, v150
  v_mul_f32 v8, s46, v150
  v_exp_f32 v8, v8
  s_nop 0
  v_add_f32 v8, 1.0, v8
  v_rcp_f32 v8, v8
  s_nop 0
  v_mul_f32 v150, v150, v8
  v_mul_f32 v151, 0x62800000, v151
  v_mul_f32 v8, s46, v151
  v_exp_f32 v8, v8
  s_nop 0
  v_add_f32 v8, 1.0, v8
  v_rcp_f32 v8, v8
  s_nop 0
  v_mul_f32 v151, v151, v8
  v_cvt_pk_bf16_f32 v8, v150, v151
  v_lshlrev_b32 v150, 16, v8
  v_and_b32 v151, s60, v8
  v_lshlrev_b32 v152, 16, v108
  v_and_b32 v153, s60, v108
  v_mul_f32 v152, 0x62800000, v152
  v_mul_f32 v8, s46, v152
  v_exp_f32 v8, v8
  s_nop 0
  v_add_f32 v8, 1.0, v8
  v_rcp_f32 v8, v8
  s_nop 0
  v_mul_f32 v152, v152, v8
  v_mul_f32 v153, 0x62800000, v153
  v_mul_f32 v8, s46, v153
  v_exp_f32 v8, v8
  s_nop 0
  v_add_f32 v8, 1.0, v8
  v_rcp_f32 v8, v8
  s_nop 0
  v_mul_f32 v153, v153, v8
  v_cvt_pk_bf16_f32 v8, v152, v153
  v_lshlrev_b32 v152, 16, v8
  v_and_b32 v153, s60, v8
  v_lshlrev_b32 v154, 16, v109
  v_and_b32 v155, s60, v109
  v_mul_f32 v154, 0x62800000, v154
  v_mul_f32 v8, s46, v154
  v_exp_f32 v8, v8
  s_nop 0
  v_add_f32 v8, 1.0, v8
  v_rcp_f32 v8, v8
  s_nop 0
  v_mul_f32 v154, v154, v8
  v_mul_f32 v155, 0x62800000, v155
  v_mul_f32 v8, s46, v155
  v_exp_f32 v8, v8
  s_nop 0
  v_add_f32 v8, 1.0, v8
  v_rcp_f32 v8, v8
  s_nop 0
  v_mul_f32 v155, v155, v8
  v_cvt_pk_bf16_f32 v8, v154, v155
  v_lshlrev_b32 v154, 16, v8
  v_and_b32 v155, s60, v8
  v_lshlrev_b32 v156, 16, v110
  v_and_b32 v157, s60, v110
  v_mul_f32 v156, 0x62800000, v156
  v_mul_f32 v8, s46, v156
  v_exp_f32 v8, v8
  s_nop 0
  v_add_f32 v8, 1.0, v8
  v_rcp_f32 v8, v8
  s_nop 0
  v_mul_f32 v156, v156, v8
  v_mul_f32 v157, 0x62800000, v157
  v_mul_f32 v8, s46, v157
  v_exp_f32 v8, v8
  s_nop 0
  v_add_f32 v8, 1.0, v8
  v_rcp_f32 v8, v8
  s_nop 0
  v_mul_f32 v157, v157, v8
  v_cvt_pk_bf16_f32 v8, v156, v157
  v_lshlrev_b32 v156, 16, v8
  v_and_b32 v157, s60, v8
  v_lshlrev_b32 v158, 16, v111
  v_and_b32 v159, s60, v111
  v_mul_f32 v158, 0x62800000, v158
  v_mul_f32 v8, s46, v158
  v_exp_f32 v8, v8
  s_nop 0
  v_add_f32 v8, 1.0, v8
  v_rcp_f32 v8, v8
  s_nop 0
  v_mul_f32 v158, v158, v8
  v_mul_f32 v159, 0x62800000, v159
  v_mul_f32 v8, s46, v159
  v_exp_f32 v8, v8
  s_nop 0
  v_add_f32 v8, 1.0, v8
  v_rcp_f32 v8, v8
  s_nop 0
  v_mul_f32 v159, v159, v8
  v_cvt_pk_bf16_f32 v8, v158, v159
  v_lshlrev_b32 v158, 16, v8
  v_and_b32 v159, s60, v8
  s_nop 1
  s_branch K2_BACK1ce1
K2_SLOWe0:
  s_waitcnt lgkmcnt(0)
  v_lshlrev_b32 v128, 16, v96
  v_and_b32 v129, s60, v96
  v_mul_f32 v128, 0x62800000, v128
  v_mul_f32 v8, s46, v128
  v_exp_f32 v8, v8
  s_nop 0
  v_add_f32 v8, 1.0, v8
  v_rcp_f32 v8, v8
  s_nop 0
  v_mul_f32 v128, v128, v8
  v_mul_f32 v129, 0x62800000, v129
  v_mul_f32 v8, s46, v129
  v_exp_f32 v8, v8
  s_nop 0
  v_add_f32 v8, 1.0, v8
  v_rcp_f32 v8, v8
  s_nop 0
  v_mul_f32 v129, v129, v8
  v_cvt_pk_bf16_f32 v8, v128, v129
  v_lshlrev_b32 v128, 16, v8
  v_and_b32 v129, s60, v8
  v_lshlrev_b32 v130, 16, v97
  v_and_b32 v131, s60, v97
  v_mul_f32 v130, 0x62800000, v130
  v_mul_f32 v8, s46, v130
  v_exp_f32 v8, v8
  s_nop 0
  v_add_f32 v8, 1.0, v8
  v_rcp_f32 v8, v8
  s_nop 0
  v_mul_f32 v130, v130, v8
  v_mul_f32 v131, 0x62800000, v131
  v_mul_f32 v8, s46, v131
  v_exp_f32 v8, v8
  s_nop 0
  v_add_f32 v8, 1.0, v8
  v_rcp_f32 v8, v8
  s_nop 0
  v_mul_f32 v131, v131, v8
  v_cvt_pk_bf16_f32 v8, v130, v131
  v_lshlrev_b32 v130, 16, v8
  v_and_b32 v131, s60, v8
  v_lshlrev_b32 v132, 16, v98
  v_and_b32 v133, s60, v98
  v_mul_f32 v132, 0x62800000, v132
  v_mul_f32 v8, s46, v132
  v_exp_f32 v8, v8
  s_nop 0
  v_add_f32 v8, 1.0, v8
  v_rcp_f32 v8, v8
  s_nop 0
  v_mul_f32 v132, v132, v8
  v_mul_f32 v133, 0x62800000, v133
  v_mul_f32 v8, s46, v133
  v_exp_f32 v8, v8
  s_nop 0
  v_add_f32 v8, 1.0, v8
  v_rcp_f32 v8, v8
  s_nop 0
  v_mul_f32 v133, v133, v8
  v_cvt_pk_bf16_f32 v8, v132, v133
  v_lshlrev_b32 v132, 16, v8
  v_and_b32 v133, s60, v8
  v_lshlrev_b32 v134, 16, v99
  v_and_b32 v135, s60, v99
  v_mul_f32 v134, 0x62800000, v134
  v_mul_f32 v8, s46, v134
  v_exp_f32 v8, v8
  s_nop 0
  v_add_f32 v8, 1.0, v8
  v_rcp_f32 v8, v8
  s_nop 0
  v_mul_f32 v134, v134, v8
  v_mul_f32 v135, 0x62800000, v135
  v_mul_f32 v8, s46, v135
  v_exp_f32 v8, v8
  s_nop 0
  v_add_f32 v8, 1.0, v8
  v_rcp_f32 v8, v8
  s_nop 0
  v_mul_f32 v135, v135, v8
  v_cvt_pk_bf16_f32 v8, v134, v135
  v_lshlrev_b32 v134, 16, v8
  v_and_b32 v135, s60, v8
  v_lshlrev_b32 v136, 16, v100
  v_and_b32 v137, s60, v100
  v_mul_f32 v136, 0x62800000, v136
  v_mul_f32 v8, s46, v136
  v_exp_f32 v8, v8
  s_nop 0
  v_add_f32 v8, 1.0, v8
  v_rcp_f32 v8, v8
  s_nop 0
  v_mul_f32 v136, v136, v8
  v_mul_f32 v137, 0x62800000, v137
  v_mul_f32 v8, s46, v137
  v_exp_f32 v8, v8
  s_nop 0
  v_add_f32 v8, 1.0, v8
  v_rcp_f32 v8, v8
  s_nop 0
  v_mul_f32 v137, v137, v8
  v_cvt_pk_bf16_f32 v8, v136, v137
  v_lshlrev_b32 v136, 16, v8
  v_and_b32 v137, s60, v8
  v_lshlrev_b32 v138, 16, v101
  v_and_b32 v139, s60, v101
  v_mul_f32 v138, 0x62800000, v138
  v_mul_f32 v8, s46, v138
  v_exp_f32 v8, v8
  s_nop 0
  v_add_f32 v8, 1.0, v8
  v_rcp_f32 v8, v8
  s_nop 0
  v_mul_f32 v138, v138, v8
  v_mul_f32 v139, 0x62800000, v139
  v_mul_f32 v8, s46, v139
  v_exp_f32 v8, v8
  s_nop 0
  v_add_f32 v8, 1.0, v8
  v_rcp_f32 v8, v8
  s_nop 0
  v_mul_f32 v139, v139, v8
  v_cvt_pk_bf16_f32 v8, v138, v139
  v_lshlrev_b32 v138, 16, v8
  v_and_b32 v139, s60, v8
  v_lshlrev_b32 v140, 16, v102
  v_and_b32 v141, s60, v102
  v_mul_f32 v140, 0x62800000, v140
  v_mul_f32 v8, s46, v140
  v_exp_f32 v8, v8
  s_nop 0
  v_add_f32 v8, 1.0, v8
  v_rcp_f32 v8, v8
  s_nop 0
  v_mul_f32 v140, v140, v8
  v_mul_f32 v141, 0x62800000, v141
  v_mul_f32 v8, s46, v141
  v_exp_f32 v8, v8
  s_nop 0
  v_add_f32 v8, 1.0, v8
  v_rcp_f32 v8, v8
  s_nop 0
  v_mul_f32 v141, v141, v8
  v_cvt_pk_bf16_f32 v8, v140, v141
  v_lshlrev_b32 v140, 16, v8
  v_and_b32 v141, s60, v8
  v_lshlrev_b32 v142, 16, v103
  v_and_b32 v143, s60, v103
  v_mul_f32 v142, 0x62800000, v142
  v_mul_f32 v8, s46, v142
  v_exp_f32 v8, v8
  s_nop 0
  v_add_f32 v8, 1.0, v8
  v_rcp_f32 v8, v8
  s_nop 0
  v_mul_f32 v142, v142, v8
  v_mul_f32 v143, 0x62800000, v143
  v_mul_f32 v8, s46, v143
  v_exp_f32 v8, v8
  s_nop 0
  v_add_f32 v8, 1.0, v8
  v_rcp_f32 v8, v8
  s_nop 0
  v_mul_f32 v143, v143, v8
  v_cvt_pk_bf16_f32 v8, v142, v143
  v_lshlrev_b32 v142, 16, v8
  v_and_b32 v143, s60, v8
  s_nop 1
  s_branch K2_BACKe0
K2_SLOWe1:
  s_waitcnt lgkmcnt(0)
  v_lshlrev_b32 v144, 16, v104
  v_and_b32 v145, s60, v104
  v_mul_f32 v144, 0x62800000, v144
  v_mul_f32 v8, s46, v144
  v_exp_f32 v8, v8
  s_nop 0
  v_add_f32 v8, 1.0, v8
  v_rcp_f32 v8, v8
  s_nop 0
  v_mul_f32 v144, v144, v8
  v_mul_f32 v145, 0x62800000, v145
  v_mul_f32 v8, s46, v145
  v_exp_f32 v8, v8
  s_nop 0
  v_add_f32 v8, 1.0, v8
  v_rcp_f32 v8, v8
  s_nop 0
  v_mul_f32 v145, v145, v8
  v_cvt_pk_bf16_f32 v8, v144, v145
  v_lshlrev_b32 v144, 16, v8
  v_and_b32 v145, s60, v8
  v_lshlrev_b32 v146, 16, v105
  v_and_b32 v147, s60, v105
  v_mul_f32 v146, 0x62800000, v146
  v_mul_f32 v8, s46, v146
  v_exp_f32 v8, v8
  s_nop 0
  v_add_f32 v8, 1.0, v8
  v_rcp_f32 v8, v8
  s_nop 0
  v_mul_f32 v146, v146, v8
  v_mul_f32 v147, 0x62800000, v147
  v_mul_f32 v8, s46, v147
  v_exp_f32 v8, v8
  s_nop 0
  v_add_f32 v8, 1.0, v8
  v_rcp_f32 v8, v8
  s_nop 0
  v_mul_f32 v147, v147, v8
  v_cvt_pk_bf16_f32 v8, v146, v147
  v_lshlrev_b32 v146, 16, v8
  v_and_b32 v147, s60, v8
  v_lshlrev_b32 v148, 16, v106
  v_and_b32 v149, s60, v106
  v_mul_f32 v148, 0x62800000, v148
  v_mul_f32 v8, s46, v148
  v_exp_f32 v8, v8
  s_nop 0
  v_add_f32 v8, 1.0, v8
  v_rcp_f32 v8, v8
  s_nop 0
  v_mul_f32 v148, v148, v8
  v_mul_f32 v149, 0x62800000, v149
  v_mul_f32 v8, s46, v149
  v_exp_f32 v8, v8
  s_nop 0
  v_add_f32 v8, 1.0, v8
  v_rcp_f32 v8, v8
  s_nop 0
  v_mul_f32 v149, v149, v8
  v_cvt_pk_bf16_f32 v8, v148, v149
  v_lshlrev_b32 v148, 16, v8
  v_and_b32 v149, s60, v8
  v_lshlrev_b32 v150, 16, v107
  v_and_b32 v151, s60, v107
  v_mul_f32 v150, 0x62800000, v150
  v_mul_f32 v8, s46, v150
  v_exp_f32 v8, v8
  s_nop 0
  v_add_f32 v8, 1.0, v8
  v_rcp_f32 v8, v8
  s_nop 0
  v_mul_f32 v150, v150, v8
  v_mul_f32 v151, 0x62800000, v151
  v_mul_f32 v8, s46, v151
  v_exp_f32 v8, v8
  s_nop 0
  v_add_f32 v8, 1.0, v8
  v_rcp_f32 v8, v8
  s_nop 0
  v_mul_f32 v151, v151, v8
  v_cvt_pk_bf16_f32 v8, v150, v151
  v_lshlrev_b32 v150, 16, v8
  v_and_b32 v151, s60, v8
  v_lshlrev_b32 v152, 16, v108
  v_and_b32 v153, s60, v108
  v_mul_f32 v152, 0x62800000, v152
  v_mul_f32 v8, s46, v152
  v_exp_f32 v8, v8
  s_nop 0
  v_add_f32 v8, 1.0, v8
  v_rcp_f32 v8, v8
  s_nop 0
  v_mul_f32 v152, v152, v8
  v_mul_f32 v153, 0x62800000, v153
  v_mul_f32 v8, s46, v153
  v_exp_f32 v8, v8
  s_nop 0
  v_add_f32 v8, 1.0, v8
  v_rcp_f32 v8, v8
  s_nop 0
  v_mul_f32 v153, v153, v8
  v_cvt_pk_bf16_f32 v8, v152, v153
  v_lshlrev_b32 v152, 16, v8
  v_and_b32 v153, s60, v8
  v_lshlrev_b32 v154, 16, v109
  v_and_b32 v155, s60, v109
  v_mul_f32 v154, 0x62800000, v154
  v_mul_f32 v8, s46, v154
  v_exp_f32 v8, v8
  s_nop 0
  v_add_f32 v8, 1.0, v8
  v_rcp_f32 v8, v8
  s_nop 0
  v_mul_f32 v154, v154, v8
  v_mul_f32 v155, 0x62800000, v155
  v_mul_f32 v8, s46, v155
  v_exp_f32 v8, v8
  s_nop 0
  v_add_f32 v8, 1.0, v8
  v_rcp_f32 v8, v8
  s_nop 0
  v_mul_f32 v155, v155, v8
  v_cvt_pk_bf16_f32 v8, v154, v155
  v_lshlrev_b32 v154, 16, v8
  v_and_b32 v155, s60, v8
  v_lshlrev_b32 v156, 16, v110
  v_and_b32 v157, s60, v110
  v_mul_f32 v156, 0x62800000, v156
  v_mul_f32 v8, s46, v156
  v_exp_f32 v8, v8
  s_nop 0
  v_add_f32 v8, 1.0, v8
  v_rcp_f32 v8, v8
  s_nop 0
  v_mul_f32 v156, v156, v8
  v_mul_f32 v157, 0x62800000, v157
  v_mul_f32 v8, s46, v157
  v_exp_f32 v8, v8
  s_nop 0
  v_add_f32 v8, 1.0, v8
  v_rcp_f32 v8, v8
  s_nop 0
  v_mul_f32 v157, v157, v8
  v_cvt_pk_bf16_f32 v8, v156, v157
  v_lshlrev_b32 v156, 16, v8
  v_and_b32 v157, s60, v8
  v_lshlrev_b32 v158, 16, v111
  v_and_b32 v159, s60, v111
  v_mul_f32 v158, 0x62800000, v158
  v_mul_f32 v8, s46, v158
  v_exp_f32 v8, v8
  s_nop 0
  v_add_f32 v8, 1.0, v8
  v_rcp_f32 v8, v8
  s_nop 0
  v_mul_f32 v158, v158, v8
  v_mul_f32 v159, 0x62800000, v159
  v_mul_f32 v8, s46, v159
  v_exp_f32 v8, v8
  s_nop 0
  v_add_f32 v8, 1.0, v8
  v_rcp_f32 v8, v8
  s_nop 0
  v_mul_f32 v159, v159, v8
  v_cvt_pk_bf16_f32 v8, v158, v159
  v_lshlrev_b32 v158, 16, v8
  v_and_b32 v159, s60, v8
  s_nop 1
  s_branch K2_BACKe1
.section .rodata,"a"
.p2align 6
.amdhsa_kernel egnn_sort_kernel
  .amdhsa_next_free_vgpr 104
  .amdhsa_next_free_sgpr 102
  .amdhsa_accum_offset 104
  .amdhsa_group_segment_fixed_size 0
  .amdhsa_kernarg_size 88
  .amdhsa_user_sgpr_count 2
  .amdhsa_user_sgpr_kernarg_segment_ptr 1
  .amdhsa_system_sgpr_workgroup_id_x 1
  .amdhsa_float_denorm_mode_32 3
.end_amdhsa_kernel
.p2align 6
.amdhsa_kernel gather_scatter__cheap_equivariant_egnn__graph_kernel
  .amdhsa_next_free_vgpr 256
  .amdhsa_next_free_sgpr 102
  .amdhsa_accum_offset 256
  .amdhsa_group_segment_fixed_size 0
  .amdhsa_kernarg_size 88
  .amdhsa_user_sgpr_count 2
  .amdhsa_user_sgpr_kernarg_segment_ptr 1
  .amdhsa_system_sgpr_workgroup_id_x 1
  .amdhsa_float_denorm_mode_32 3
.end_amdhsa_kernel
```
